```python
import torch

def _softmax(x, axis=-1):
    return torch.softmax(x, dim=axis)
def _gelu(x):
    return torch.nn.functional.gelu(x, approximate="tanh")
def _silu(x):
    return torch.nn.functional.silu(x)
def _sigmoid(x):
    return torch.sigmoid(x)
def _layernorm(x, axis=-1, eps=1e-5):
    m = x.mean(dim=axis, keepdim=True)
    v = x.var(dim=axis, keepdim=True, unbiased=False)
    return (x - m) / torch.sqrt(v + eps)
def _scatter_add(tgt, idx, src, axis=0):
    return tgt.clone().index_add_(axis, idx, src)
def _segment_sum(src, seg, n):
    out = torch.zeros((n,) + src.shape[1:], dtype=src.dtype)
    return out.index_add_(0, seg, src)
def _pad(x, pw):
    flat = tuple(v for pair in reversed(pw) for v in pair)
    return torch.nn.functional.pad(x, flat)

kernel_name = 'gated_mix__spectral_fnet__geglu_ffn__prompt'

def setup_inputs():

    _w = (lambda a: (lambda t: t.to(torch.bfloat16) if t.is_floating_point() else t)(torch.as_tensor(a)))
    def _A_setup():
        B, S, D = 1, 2048, 512
        ns = torch.arange(S)[:, None] * torch.arange(S)[None, :]
        nd = torch.arange(D)[:, None] * torch.arange(D)[None, :]
        Ws_re = torch.cos(-2.0 * torch.pi * ns / S).to(float)
        Ws_im = torch.sin(-2.0 * torch.pi * ns / S).to(float)
        Wd_re = torch.cos(-2.0 * torch.pi * nd / D).to(float)
        Wd_im = torch.sin(-2.0 * torch.pi * nd / D).to(float)
        return {
            "x": _w((lambda *s: torch.randn(*s, dtype=torch.bfloat16) * 0.05)(B, S, D)),
            "dft_seq_re": _w(Ws_re),
            "dft_seq_im": _w(Ws_im),
            "dft_hid_re": _w(Wd_re),
            "dft_hid_im": _w(Wd_im),
        }
    _A_in = _A_setup()

    def _B_setup():
        B, S, D, F = 1, 2048, 512, 1376
        return {
            "x": _w((lambda *s: torch.randn(*s, dtype=torch.bfloat16) * 0.05)(B, S, D)),
            "w_gate": _w((lambda *s: torch.randn(*s, dtype=torch.bfloat16) * 0.8)(D, F)),
            "w_up": _w((lambda *s: torch.randn(*s, dtype=torch.bfloat16) * 0.8)(D, F)),
            "w_down": _w((lambda *s: torch.randn(*s, dtype=torch.bfloat16) * 0.8)(F, D)),
        }
    _B_in = _B_setup()

    return {
        "A_x": _A_in["x"],
        "A_dft_seq_re": _A_in["dft_seq_re"],
        "A_dft_seq_im": _A_in["dft_seq_im"],
        "A_dft_hid_re": _A_in["dft_hid_re"],
        "A_dft_hid_im": _A_in["dft_hid_im"],
        "B_x": _B_in["x"],
        "B_w_gate": _B_in["w_gate"],
        "B_w_up": _B_in["w_up"],
        "B_w_down": _B_in["w_down"],
        "gate_w": _w((lambda *s: torch.randn(*s, dtype=torch.bfloat16) * 0.05)(512) * 16.0),
    }

def reference(A_x, A_dft_seq_re, A_dft_seq_im, A_dft_hid_re, A_dft_hid_im, B_x, B_w_gate, B_w_up, B_w_down, gate_w):
    def _A_ref(x, dft_seq_re, dft_seq_im, dft_hid_re, dft_hid_im):
        a = torch.einsum("bsd,ed->bse", x, dft_hid_re)
        b = torch.einsum("bsd,ed->bse", x, dft_hid_im)
        y = torch.einsum("ts,bse->bte", dft_seq_re, a) - torch.einsum("ts,bse->bte", dft_seq_im, b)
        return y

    def _B_ref(x, w_gate, w_up, w_down):
        return (_gelu(x @ w_gate) * (x @ w_up)) @ w_down

    x = A_x
    g = _sigmoid((x * gate_w).sum(-1, keepdims=True))
    a = _A_ref(x, A_dft_seq_re, A_dft_seq_im, A_dft_hid_re, A_dft_hid_im)
    b = _B_ref(x, B_w_gate, B_w_up, B_w_down)
    return g * a + (1 - g) * b
```

```asm
; @launch grid=(256,1,1) block=(512,1,1) lds=163840
.amdgcn_target "amdgcn-amd-amdhsa--gfx950"
.text
.globl gated_mix__spectral_fnet__geglu_ffn__prompt_kernel
.p2align 8
.type gated_mix__spectral_fnet__geglu_ffn__prompt_kernel,@function
gated_mix__spectral_fnet__geglu_ffn__prompt_kernel:
    s_cmp_ge_u32 s2, 256
    s_cbranch_scc1 K_END
    s_load_dwordx2 s[32:33], s[0:1], 0
    s_load_dwordx16 s[4:19], s[0:1], 0
    s_load_dwordx8 s[20:27], s[0:1], 64
    s_load_dwordx2 s[28:29], s[0:1], 96
    v_lshrrev_b32 v1, 6, v0
    v_and_b32 v0, 63, v0
    v_readfirstlane_b32 s95, v1
    s_cmp_lg_u32 s95, 4
    s_cbranch_scc1 NOCPF
    s_getpc_b64 s[84:85]
CPF_PC:
    s_sub_u32 s84, s84, CPF_PC-gated_mix__spectral_fnet__geglu_ffn__prompt_kernel
    s_subb_u32 s85, s85, 0
    s_lshr_b32 s30, s2, 3
    s_lshl_b32 s30, s30, 10
    v_and_b32 v1, 7, v0
    v_lshl_add_u32 v1, v1, 7, s30
    v_min_u32 v1, K_END-gated_mix__spectral_fnet__geglu_ffn__prompt_kernel, v1
    v_mov_b32 v3, s85
    v_add_co_u32 v2, vcc, s84, v1
    s_nop 1
    v_addc_co_u32 v3, vcc, 0, v3, vcc
    s_mov_b64 exec, 0xff
    global_load_dword v13, v[2:3], off
    s_mov_b64 exec, -1
NOCPF:
    s_mov_b32 s96, 0x30630630
    s_mov_b32 s97, 0x306
    s_lshr_b32 s31, s2, 3
    s_and_b32 s56, s2, 1
    s_lshl_b32 s56, s56, 3
    s_and_b32 s74, s31, 7
    s_add_u32 s56, s56, s74
    s_and_b32 s57, s2, 6
    s_lshl_b32 s57, s57, 1
    s_lshr_b32 s75, s31, 3
    s_add_u32 s57, s57, s75
    s_add_u32 s74, s74, s75
    s_lshl_b32 s74, s74, 2
    s_lshr_b64 s[74:75], s[96:97], s74
    s_and_b32 s74, s74, 7
    s_and_b32 s30, s57, 7
    s_cselect_b32 s58, 0, 1
    s_lshr_b32 s59, s57, 3
    s_sub_u32 s78, s57, s59
    s_sub_u32 s78, s78, 1
    s_and_b32 s3, s95, 3
    s_cmp_ge_u32 s95, 4
    s_cbranch_scc1 P1_CONS
    v_lshrrev_b32 v3, 3, v0
    v_and_b32 v8, 7, v0
    v_lshrrev_b32 v9, 4, v0
    s_lshl_b32 s30, s56, 2
    s_add_u32 s30, s30, s3
    s_lshl_b32 s79, s30, 10
    s_lshl_b32 s66, s3, 12
    s_lshl_b32 s70, s74, 7
    s_cmp_eq_u32 s58, 1
    s_cbranch_scc1 P1_LSP
    v_xor_b32 v10, v9, v8
    v_lshlrev_b32 v10, 4, v10
    v_lshlrev_b32 v11, 16, v3
    v_add3_u32 v4, v10, v11, s79
    v_xor_b32 v5, 64, v4
    v_add_u32 v5, 523264, v5
    v_add_u32 v6, 1046528, v4
    v_add_u32 v7, 1046528, v5
    s_mov_b32 s34, 0x200000
    s_mov_b32 s35, 0x20000
    s_mov_b32 m0, s66
    s_mul_i32 s30, s3, 44032
    s_mul_i32 s31, s78, 192
    s_add_u32 s30, s30, s31
    s_movk_i32 s31, 2560
    v_mul_u32_u24 v11, 171, v0
    v_lshl_add_u32 v10, v0, 4, s30
    v_lshrrev_b32 v12, 11, v11
    v_mad_u32_u24 v24, v12, s31, v10
    v_add_u32 v12, 10944, v11
    v_lshrrev_b32 v12, 11, v12
    v_and_b32 v25, 32, v0
    v_xor_b32 v25, v25, v10
    v_mad_u32_u24 v25, v12, s31, v25
    v_add_u32 v12, 21888, v11
    v_lshrrev_b32 v12, 11, v12
    v_xor_b32 v26, 32, v10
    v_mad_u32_u24 v26, v12, s31, v26
    s_mul_i32 s67, s3, 3072
    s_add_u32 s67, s67, 16384
    s_add_u32 s68, s67, 12288
    s_mul_i32 s71, s74, 176128
    s_waitcnt lgkmcnt(0)
    buffer_load_dwordx4 v4, s[32:35], s70 offen offset:0  lds
    buffer_load_dwordx4 v5, s[32:35], s70 offen offset:1024  lds
    buffer_load_dwordx4 v6, s[32:35], s70 offen offset:2048  lds
    buffer_load_dwordx4 v7, s[32:35], s70 offen offset:3072  lds
    s_mov_b32 s36, s16
    s_mov_b32 s37, s17
    s_mov_b32 s38, 0x158000
    s_mov_b32 s39, 0x20000
    s_add_u32 m0, s67, 0
    s_add_u32 s74, s74, 1
    buffer_load_dwordx4 v24, s[36:39], s71 offen offset:0  lds
    buffer_load_dwordx4 v25, s[36:39], s71 offen offset:1024  lds
    buffer_load_dwordx4 v26, s[36:39], s71 offen offset:2048  lds
    s_mov_b32 s40, s18
    s_mov_b32 s41, s19
    s_mov_b32 s42, 0x158000
    s_mov_b32 s43, 0x20000
    s_add_u32 m0, s68, 0
    s_and_b32 s74, s74, 7
    buffer_load_dwordx4 v24, s[40:43], s71 offen offset:0  lds
    buffer_load_dwordx4 v25, s[40:43], s71 offen offset:1024  lds
    buffer_load_dwordx4 v26, s[40:43], s71 offen offset:2048  lds
    s_lshl_b32 s70, s74, 7
    s_mul_i32 s71, s74, 176128
    s_mov_b32 s44, s28
    s_mov_b32 s45, s29
    s_mov_b32 s46, 0x920000
    s_mov_b32 s47, 0x20000
    s_and_b32 s30, s2, 7
    s_lshr_b32 s31, s2, 3
    s_lshr_b32 s93, s31, 2
    s_xor_b32 s93, s93, 5
    s_and_b32 s31, s31, 3
    s_mul_i32 s94, s31, 6
    s_sub_u32 s61, 0, s30
    s_bitcmp1_b32 s31, 0
    s_cselect_b32 s92, s61, s30
    s_cselect_b32 s61, 8, 0
    s_cmp_eq_u32 s30, 0
    s_cselect_b32 s92, s61, s92
    s_lshr_b32 s31, s31, 1
    s_lshl_b32 s31, s31, 4
    s_add_u32 s92, s92, s31
    s_and_b32 s92, s92, 31
    s_mul_i32 s30, s93, 0
    s_add_u32 s94, s94, s30
    s_sub_u32 s30, s94, 22
    s_cmp_ge_u32 s94, 22
    s_cselect_b32 s94, s30, s94
    s_mov_b32 s52, s20
    s_mov_b32 s53, s21
    s_mov_b32 s54, 0x158000
    s_mov_b32 s55, 0x20000
    v_lshlrev_b32 v29, 1, v3
    v_and_b32 v29, 4, v29
    v_xor_b32 v29, v29, v8
    v_lshlrev_b32 v29, 4, v29
    v_lshl_add_u32 v29, v3, 10, v29
    s_mul_i32 s30, s3, 360448
    s_lshl_b32 s31, s93, 7
    s_add_u32 s30, s30, s31
    v_add_u32 v29, s30, v29
    s_mov_b32 s65, s94
    s_mul_i32 s77, s3, 10240
    v_lshrrev_b32 v232, 5, v0
    v_and_b32 v233, 15, v0
    v_lshrrev_b32 v234, 2, v233
    v_lshl_add_u32 v234, v232, 3, v234
    v_lshlrev_b32 v234, 7, v234
    v_lshrrev_b32 v235, 3, v233
    v_lshl_add_u32 v234, v235, 6, v234
    v_and_b32 v235, 16, v0
    v_lshl_add_u32 v234, v235, 1, v234
    v_and_b32 v235, 3, v0
    v_lshl_add_u32 v234, v235, 3, v234
    v_add_u32 v226, s77, v234
    v_xor_b32 v227, 64, v226
    v_add_u32 v228, 81920, v226
    v_add_u32 v229, 81920, v227
    s_mul_i32 s31, s3, 22
    s_mul_i32 s30, s92, 86
    s_add_u32 s30, s30, s31
    s_lshl_b32 s30, s30, 10
    v_lshlrev_b32 v232, 4, v0
    v_add_u32 v224, s30, v232
    v_add_u32 v225, 2818048, v224
    s_cmp_eq_u32 s3, 3
    s_cselect_b32 s72, 20, 22
    s_cselect_b32 s30, 20, 16
    v_mov_b32 v231, s30
    s_lshr_b32 s30, s92, 1
    s_lshl_b32 s30, s30, 2
    s_add_u32 s30, s30, s3
    s_lshl_b32 s30, s30, 7
    v_mov_b32 v230, s30
    v_add_u32 v240, s77, v232
    v_xor_b32 v241, 64, v240
    v_xor_b32 v242, 128, v240
    v_xor_b32 v243, 192, v240
    v_add_u32 v244, 81920, v240
    v_add_u32 v245, 81920, v241
    v_add_u32 v246, 81920, v242
    v_add_u32 v247, 81920, v243
    s_lshr_b32 s30, s95, 2
    v_lshrrev_b32 v248, 3, v0
    s_lshl_b32 s31, s3, 3
    v_add_u32 v248, s31, v248
    v_and_b32 v249, 3, v0
    v_lshlrev_b32 v250, 2, v249
    v_xor_b32 v250, v250, v248
    v_lshlrev_b32 v250, 4, v250
    v_lshl_add_u32 v250, v249, 10, v250
    v_bfe_u32 v249, v0, 2, 1
    s_lshl_b32 s31, s30, 1
    v_add_u32 v249, s31, v249
    v_mul_u32_u24 v251, 10240, v249
    v_add_u32 v251, v251, v250
    v_mul_u32_u24 v249, 40960, v249
    v_add_u32 v249, v249, v250
    s_lshl_b32 s31, s30, 7
    v_lshl_add_u32 v250, v248, 2, s31
    s_lshl_b32 s30, s30, 5
    s_add_u32 s30, s30, s92
    s_lshl_b32 s30, s30, 10
    s_lshl_b32 s31, s93, 7
    s_add_u32 s30, s30, s31
    v_lshlrev_b32 v248, 16, v248
    v_add_u32 v248, s30, v248
    v_and_b32 v252, 7, v0
    v_lshl_add_u32 v248, v252, 4, v248
    s_add_u32 m0, s66, 40960
    s_nop 0
    buffer_load_dwordx4 v4, s[32:35], s70 offen offset:0  lds
    buffer_load_dwordx4 v5, s[32:35], s70 offen offset:1024  lds
    buffer_load_dwordx4 v6, s[32:35], s70 offen offset:2048  lds
    buffer_load_dwordx4 v7, s[32:35], s70 offen offset:3072  lds
    s_add_u32 m0, s67, 40960
    s_add_u32 s74, s74, 1
    buffer_load_dwordx4 v24, s[36:39], s71 offen offset:0  lds
    buffer_load_dwordx4 v25, s[36:39], s71 offen offset:1024  lds
    buffer_load_dwordx4 v26, s[36:39], s71 offen offset:2048  lds
    s_waitcnt vmcnt(7)
    s_barrier
    s_add_u32 m0, s68, 40960
    s_and_b32 s74, s74, 7
    buffer_load_dwordx4 v24, s[40:43], s71 offen offset:0  lds
    buffer_load_dwordx4 v25, s[40:43], s71 offen offset:1024  lds
    buffer_load_dwordx4 v26, s[40:43], s71 offen offset:2048  lds
    s_lshl_b32 s70, s74, 7
    s_mul_i32 s71, s74, 176128
    s_add_u32 m0, s66, 81920
    s_nop 0
    buffer_load_dwordx4 v4, s[32:35], s70 offen offset:0  lds
    buffer_load_dwordx4 v5, s[32:35], s70 offen offset:1024  lds
    buffer_load_dwordx4 v6, s[32:35], s70 offen offset:2048  lds
    buffer_load_dwordx4 v7, s[32:35], s70 offen offset:3072  lds
    s_add_u32 m0, s67, 81920
    s_add_u32 s74, s74, 1
    buffer_load_dwordx4 v24, s[36:39], s71 offen offset:0  lds
    buffer_load_dwordx4 v25, s[36:39], s71 offen offset:1024  lds
    buffer_load_dwordx4 v26, s[36:39], s71 offen offset:2048  lds
    s_waitcnt vmcnt(7)
    s_barrier
    s_add_u32 m0, s68, 81920
    s_and_b32 s74, s74, 7
    buffer_load_dwordx4 v24, s[40:43], s71 offen offset:0  lds
    buffer_load_dwordx4 v25, s[40:43], s71 offen offset:1024  lds
    buffer_load_dwordx4 v26, s[40:43], s71 offen offset:2048  lds
    s_lshl_b32 s70, s74, 7
    s_mul_i32 s71, s74, 176128
    s_add_u32 m0, s66, 122880
    s_nop 0
    buffer_load_dwordx4 v4, s[32:35], s70 offen offset:0  lds
    buffer_load_dwordx4 v5, s[32:35], s70 offen offset:1024  lds
    buffer_load_dwordx4 v6, s[32:35], s70 offen offset:2048  lds
    buffer_load_dwordx4 v7, s[32:35], s70 offen offset:3072  lds
    s_add_u32 m0, s67, 122880
    s_add_u32 s74, s74, 1
    buffer_load_dwordx4 v24, s[36:39], s71 offen offset:0  lds
    buffer_load_dwordx4 v25, s[36:39], s71 offen offset:1024  lds
    buffer_load_dwordx4 v26, s[36:39], s71 offen offset:2048  lds
    s_waitcnt vmcnt(7)
    s_barrier
    s_add_u32 m0, s68, 122880
    s_and_b32 s74, s74, 7
    buffer_load_dwordx4 v24, s[40:43], s71 offen offset:0  lds
    buffer_load_dwordx4 v25, s[40:43], s71 offen offset:1024  lds
    buffer_load_dwordx4 v26, s[40:43], s71 offen offset:2048  lds
    s_lshl_b32 s70, s74, 7
    s_mul_i32 s71, s74, 176128
    s_add_u32 m0, s66, 0
    s_nop 0
    buffer_load_dwordx4 v4, s[32:35], s70 offen offset:0  lds
    buffer_load_dwordx4 v5, s[32:35], s70 offen offset:1024  lds
    buffer_load_dwordx4 v6, s[32:35], s70 offen offset:2048  lds
    buffer_load_dwordx4 v7, s[32:35], s70 offen offset:3072  lds
    s_add_u32 m0, s67, 0
    s_add_u32 s74, s74, 1
    buffer_load_dwordx4 v24, s[36:39], s71 offen offset:0  lds
    buffer_load_dwordx4 v25, s[36:39], s71 offen offset:1024  lds
    buffer_load_dwordx4 v26, s[36:39], s71 offen offset:2048  lds
    s_waitcnt vmcnt(7)
    s_barrier
    s_add_u32 m0, s68, 0
    s_and_b32 s74, s74, 7
    buffer_load_dwordx4 v24, s[40:43], s71 offen offset:0  lds
    buffer_load_dwordx4 v25, s[40:43], s71 offen offset:1024  lds
    buffer_load_dwordx4 v26, s[40:43], s71 offen offset:2048  lds
    s_lshl_b32 s70, s74, 7
    s_mul_i32 s71, s74, 176128
    s_add_u32 m0, s66, 40960
    s_nop 0
    buffer_load_dwordx4 v4, s[32:35], s70 offen offset:0  lds
    buffer_load_dwordx4 v5, s[32:35], s70 offen offset:1024  lds
    buffer_load_dwordx4 v6, s[32:35], s70 offen offset:2048  lds
    buffer_load_dwordx4 v7, s[32:35], s70 offen offset:3072  lds
    s_add_u32 m0, s67, 40960
    s_add_u32 s74, s74, 1
    buffer_load_dwordx4 v24, s[36:39], s71 offen offset:0  lds
    buffer_load_dwordx4 v25, s[36:39], s71 offen offset:1024  lds
    buffer_load_dwordx4 v26, s[36:39], s71 offen offset:2048  lds
    s_waitcnt vmcnt(7)
    s_barrier
    s_add_u32 m0, s68, 40960
    s_and_b32 s74, s74, 7
    buffer_load_dwordx4 v24, s[40:43], s71 offen offset:0  lds
    buffer_load_dwordx4 v25, s[40:43], s71 offen offset:1024  lds
    buffer_load_dwordx4 v26, s[40:43], s71 offen offset:2048  lds
    s_lshl_b32 s70, s74, 7
    s_mul_i32 s71, s74, 176128
    s_add_u32 m0, s66, 81920
    s_nop 0
    buffer_load_dwordx4 v4, s[32:35], s70 offen offset:0  lds
    buffer_load_dwordx4 v5, s[32:35], s70 offen offset:1024  lds
    buffer_load_dwordx4 v6, s[32:35], s70 offen offset:2048  lds
    buffer_load_dwordx4 v7, s[32:35], s70 offen offset:3072  lds
    s_add_u32 m0, s67, 81920
    s_add_u32 s74, s74, 1
    buffer_load_dwordx4 v24, s[36:39], s71 offen offset:0  lds
    buffer_load_dwordx4 v25, s[36:39], s71 offen offset:1024  lds
    buffer_load_dwordx4 v26, s[36:39], s71 offen offset:2048  lds
    s_waitcnt vmcnt(7)
    s_barrier
    s_add_u32 m0, s68, 81920
    s_and_b32 s74, s74, 7
    buffer_load_dwordx4 v24, s[40:43], s71 offen offset:0  lds
    buffer_load_dwordx4 v25, s[40:43], s71 offen offset:1024  lds
    buffer_load_dwordx4 v26, s[40:43], s71 offen offset:2048  lds
    s_lshl_b32 s70, s74, 7
    s_mul_i32 s71, s74, 176128
    s_add_u32 m0, s66, 122880
    s_nop 0
    buffer_load_dwordx4 v4, s[32:35], s70 offen offset:0  lds
    buffer_load_dwordx4 v5, s[32:35], s70 offen offset:1024  lds
    buffer_load_dwordx4 v6, s[32:35], s70 offen offset:2048  lds
    buffer_load_dwordx4 v7, s[32:35], s70 offen offset:3072  lds
    s_add_u32 m0, s67, 122880
    s_add_u32 s74, s74, 1
    buffer_load_dwordx4 v24, s[36:39], s71 offen offset:0  lds
    buffer_load_dwordx4 v25, s[36:39], s71 offen offset:1024  lds
    buffer_load_dwordx4 v26, s[36:39], s71 offen offset:2048  lds
    s_waitcnt vmcnt(7)
    s_barrier
    s_add_u32 m0, s68, 122880
    s_and_b32 s74, s74, 7
    buffer_load_dwordx4 v24, s[40:43], s71 offen offset:0  lds
    buffer_load_dwordx4 v25, s[40:43], s71 offen offset:1024  lds
    buffer_load_dwordx4 v26, s[40:43], s71 offen offset:2048  lds
    s_lshl_b32 s70, s74, 7
    s_mul_i32 s71, s74, 176128
    s_lshr_b32 s30, s2, 3
    s_lshl_b32 s30, s30, 2
    s_add_u32 s30, s30, s3
    s_mul_i32 s30, s30, 11264
    v_lshlrev_b32 v12, 10, v0
    s_mov_b64 exec, 0x7ff
    buffer_load_dword v82, v12, s[52:55], s30 offen offset:384
    s_mov_b64 exec, -1
    s_add_u32 m0, s77, 0
    s_lshl_b32 s30, s65, 14
    s_add_u32 s31, s30, 7168
    buffer_load_dwordx4 v29, s[52:55], s30 offen lds
    s_add_u32 s65, s65, 1
    s_cmp_eq_u32 s65, 22
    s_cselect_b32 s65, 0, s65
    buffer_load_dwordx4 v29, s[52:55], s31 offen offset:1024 lds
    s_add_u32 m0, s77, 2048
    s_lshl_b32 s30, s65, 14
    s_add_u32 s31, s30, 7168
    buffer_load_dwordx4 v29, s[52:55], s30 offen lds
    s_add_u32 s65, s65, 1
    s_cmp_eq_u32 s65, 22
    s_cselect_b32 s65, 0, s65
    buffer_load_dwordx4 v29, s[52:55], s31 offen offset:1024 lds
    s_waitcnt vmcnt(5)
    s_barrier
    s_load_dwordx8 s[4:11], s[26:27], 0
    s_add_u32 m0, s77, 4096
    s_lshl_b32 s30, s65, 14
    s_add_u32 s31, s30, 7168
    buffer_load_dwordx4 v29, s[52:55], s30 offen lds
    s_add_u32 s65, s65, 1
    s_cmp_eq_u32 s65, 22
    s_cselect_b32 s65, 0, s65
    buffer_load_dwordx4 v29, s[52:55], s31 offen offset:1024 lds
    s_add_u32 m0, s77, 6144
    s_lshl_b32 s30, s65, 14
    s_add_u32 s31, s30, 7168
    buffer_load_dwordx4 v29, s[52:55], s30 offen lds
    s_add_u32 s65, s65, 1
    s_cmp_eq_u32 s65, 22
    s_cselect_b32 s65, 0, s65
    buffer_load_dwordx4 v29, s[52:55], s31 offen offset:1024 lds
    s_waitcnt lgkmcnt(0)
    s_and_b64 s[4:5], s[4:5], s[6:7]
    s_and_b64 s[8:9], s[8:9], s[10:11]
    s_and_b64 s[4:5], s[4:5], s[8:9]
    s_and_b32 s4, s4, s5
    s_cbranch_scc1 NOKLF
    s_mov_b32 s48, s26
    s_mov_b32 s49, s27
    s_mov_b32 s50, 0x100
    s_mov_b32 s51, 0x20000
    s_mov_b32 s61, 0
    v_lshlrev_b32 v31, 2, v0
    s_mov_b64 exec, 0xff
NLLF:
    v_mov_b32 v30, 0
    buffer_atomic_add v30, v31, s[48:51], 0 offen sc0 sc1
    s_add_u32 s61, s61, 1
    s_cmp_gt_u32 s61, 400000
    s_waitcnt vmcnt(0)
    s_cbranch_scc1 NXLF
    v_cmp_eq_u32 vcc, 0, v30
    s_cbranch_vccnz NLLF
NXLF:
    s_mov_b64 exec, -1
NOKLF:
    s_barrier
    s_branch P2_W4
P1_LSP:
    v_lshlrev_b32 v10, 4, v8
    v_lshlrev_b32 v11, 16, v3
    v_add3_u32 v4, v10, v11, s79
    s_and_b32 s30, s3, 1
    s_lshl_b32 s30, s30, 5
    s_lshr_b32 s31, s3, 1
    s_add_u32 s30, s30, s31
    s_lshl_b32 s30, s30, 10
    s_lshl_b32 s31, s59, 7
    s_add_u32 s30, s30, s31
    v_and_b32 v10, 2, v3
    v_xor_b32 v10, v10, v8
    v_lshlrev_b32 v10, 4, v10
    v_lshlrev_b32 v11, 11, v3
    v_add3_u32 v24, v10, v11, s30
    v_xor_b32 v25, 64, v24
    v_lshrrev_b32 v10, 1, v0
    s_lshl_b32 s30, s3, 1
    s_and_b32 s30, s30, 4
    v_xor_b32 v10, s30, v10
    v_mul_u32_u24 v10, 5504, v10
    v_and_b32 v11, 1, v0
    v_lshlrev_b32 v11, 4, v11
    s_and_b32 s30, s3, 1
    s_mul_i32 s30, s30, 2752
    s_lshl_b32 s31, s59, 5
    s_add_u32 s30, s30, s31
    s_add_u32 s30, s30, 2688
    v_add3_u32 v26, v10, v11, s30
    s_lshl_b32 s67, s3, 11
    s_add_u32 s67, s67, 16384
    s_add_u32 s68, s67, 8192
    s_lshl_b32 s69, s3, 10
    s_add_u32 s69, s69, 32768
    s_lshl_b32 s71, s74, 16
    s_mul_i32 s75, s74, 176128
    s_mov_b32 s34, 0x200000
    s_mov_b32 s35, 0x20000
    s_waitcnt lgkmcnt(0)
    buffer_load_dwordx4 v[32:35], v4, s[32:35], s70 offen
    s_add_u32 s30, s70, 524288
    buffer_load_dwordx4 v[36:39], v4, s[32:35], s30 offen
    s_add_u32 s30, s70, 1048576
    buffer_load_dwordx4 v[40:43], v4, s[32:35], s30 offen
    s_add_u32 s30, s70, 1572864
    buffer_load_dwordx4 v[44:47], v4, s[32:35], s30 offen
    s_add_u32 s74, s74, 1
    s_mov_b32 s36, s10
    s_mov_b32 s37, s11
    s_mov_b32 s38, 0x80000
    s_mov_b32 s39, 0x20000
    s_mov_b32 s40, s12
    s_mov_b32 s41, s13
    s_mov_b32 s42, 0x80000
    s_mov_b32 s43, 0x20000
    s_cmp_ge_u32 s3, 2
    s_cselect_b32 s84, s18, s16
    s_cselect_b32 s85, s19, s17
    s_mov_b32 s86, 0x158000
    s_mov_b32 s87, 0x20000
    s_mov_b32 s44, s28
    s_mov_b32 s45, s29
    s_mov_b32 s46, 0x920000
    s_mov_b32 s47, 0x20000
    s_add_u32 m0, s67, 0
    s_add_u32 s76, s71, 15360
    buffer_load_dwordx4 v24, s[36:39], s71 offen lds
    buffer_load_dwordx4 v24, s[36:39], s76 offen offset:1024 lds
    s_add_u32 m0, s68, 0
    s_nop 0
    buffer_load_dwordx4 v25, s[40:43], s71 offen lds
    buffer_load_dwordx4 v25, s[40:43], s76 offen offset:1024 lds
    s_add_u32 m0, s69, 0
    s_and_b32 s74, s74, 7
    buffer_load_dwordx4 v26, s[84:87], s75 offen lds
    s_lshl_b32 s70, s74, 7
    s_lshl_b32 s71, s74, 16
    s_mul_i32 s75, s74, 176128
    v_lshrrev_b32 v10, 1, v8
    v_xor_b32 v10, v10, v9
    v_lshlrev_b32 v10, 4, v10
    v_and_b32 v11, 1, v8
    v_lshl_add_u32 v10, v11, 3, v10
    v_lshl_add_u32 v10, v3, 7, v10
    v_add_u32 v5, s66, v10
    v_and_b32 v11, 1, v3
    v_lshlrev_b32 v10, 6, v11
    v_xor_b32 v5, v5, v10
    v_xor_b32 v6, 64, v5
    v_mul_u32_u24 v30, 0x0202, v11
    v_lshl_or_b32 v30, v30, 16, v30
    v_xor_b32 v31, 0x07060302, v30
    v_xor_b32 v30, 0x05040100, v30
    v_and_b32 v10, 2, v0
    v_or_b32 v10, 4, v10
    v_lshlrev_b32 v10, 4, v10
    v_lshl_add_u32 v10, v0, 7, v10
    v_add_u32 v27, s68, v10
    s_lshr_b32 s30, s3, 1
    v_xor_b32 v28, s30, v0
    v_and_b32 v28, 1, v28
    v_lshlrev_b32 v28, 15, v28
    v_or_b32 v28, 0x3f80, v28
    s_and_b32 s30, s2, 7
    s_lshr_b32 s31, s2, 3
    s_lshr_b32 s93, s31, 2
    s_xor_b32 s93, s93, 5
    s_and_b32 s31, s31, 3
    s_mul_i32 s94, s31, 6
    s_sub_u32 s61, 0, s30
    s_bitcmp1_b32 s31, 0
    s_cselect_b32 s92, s61, s30
    s_cselect_b32 s61, 8, 0
    s_cmp_eq_u32 s30, 0
    s_cselect_b32 s92, s61, s92
    s_lshr_b32 s31, s31, 1
    s_lshl_b32 s31, s31, 4
    s_add_u32 s92, s92, s31
    s_and_b32 s92, s92, 31
    s_mul_i32 s30, s93, 0
    s_add_u32 s94, s94, s30
    s_sub_u32 s30, s94, 22
    s_cmp_ge_u32 s94, 22
    s_cselect_b32 s94, s30, s94
    s_mov_b32 s52, s20
    s_mov_b32 s53, s21
    s_mov_b32 s54, 0x158000
    s_mov_b32 s55, 0x20000
    v_lshlrev_b32 v29, 1, v3
    v_and_b32 v29, 4, v29
    v_xor_b32 v29, v29, v8
    v_lshlrev_b32 v29, 4, v29
    v_lshl_add_u32 v29, v3, 10, v29
    s_mul_i32 s30, s3, 360448
    s_lshl_b32 s31, s93, 7
    s_add_u32 s30, s30, s31
    v_add_u32 v29, s30, v29
    s_mov_b32 s65, s94
    s_mul_i32 s77, s3, 10240
    v_lshrrev_b32 v232, 5, v0
    v_and_b32 v233, 15, v0
    v_lshrrev_b32 v234, 2, v233
    v_lshl_add_u32 v234, v232, 3, v234
    v_lshlrev_b32 v234, 7, v234
    v_lshrrev_b32 v235, 3, v233
    v_lshl_add_u32 v234, v235, 6, v234
    v_and_b32 v235, 16, v0
    v_lshl_add_u32 v234, v235, 1, v234
    v_and_b32 v235, 3, v0
    v_lshl_add_u32 v234, v235, 3, v234
    v_add_u32 v226, s77, v234
    v_xor_b32 v227, 64, v226
    v_add_u32 v228, 81920, v226
    v_add_u32 v229, 81920, v227
    s_mul_i32 s31, s3, 22
    s_mul_i32 s30, s92, 86
    s_add_u32 s30, s30, s31
    s_lshl_b32 s30, s30, 10
    v_lshlrev_b32 v232, 4, v0
    v_add_u32 v224, s30, v232
    v_add_u32 v225, 2818048, v224
    s_cmp_eq_u32 s3, 3
    s_cselect_b32 s72, 20, 22
    s_cselect_b32 s30, 20, 16
    v_mov_b32 v231, s30
    s_lshr_b32 s30, s92, 1
    s_lshl_b32 s30, s30, 2
    s_add_u32 s30, s30, s3
    s_lshl_b32 s30, s30, 7
    v_mov_b32 v230, s30
    v_add_u32 v240, s77, v232
    v_xor_b32 v241, 64, v240
    v_xor_b32 v242, 128, v240
    v_xor_b32 v243, 192, v240
    v_add_u32 v244, 81920, v240
    v_add_u32 v245, 81920, v241
    v_add_u32 v246, 81920, v242
    v_add_u32 v247, 81920, v243
    s_lshr_b32 s30, s95, 2
    v_lshrrev_b32 v248, 3, v0
    s_lshl_b32 s31, s3, 3
    v_add_u32 v248, s31, v248
    v_and_b32 v249, 3, v0
    v_lshlrev_b32 v250, 2, v249
    v_xor_b32 v250, v250, v248
    v_lshlrev_b32 v250, 4, v250
    v_lshl_add_u32 v250, v249, 10, v250
    v_bfe_u32 v249, v0, 2, 1
    s_lshl_b32 s31, s30, 1
    v_add_u32 v249, s31, v249
    v_mul_u32_u24 v251, 10240, v249
    v_add_u32 v251, v251, v250
    v_mul_u32_u24 v249, 40960, v249
    v_add_u32 v249, v249, v250
    s_lshl_b32 s31, s30, 7
    v_lshl_add_u32 v250, v248, 2, s31
    s_lshl_b32 s30, s30, 5
    s_add_u32 s30, s30, s92
    s_lshl_b32 s30, s30, 10
    s_lshl_b32 s31, s93, 7
    s_add_u32 s30, s30, s31
    v_lshlrev_b32 v248, 16, v248
    v_add_u32 v248, s30, v248
    v_and_b32 v252, 7, v0
    v_lshl_add_u32 v248, v252, 4, v248
    buffer_load_dwordx4 v[48:51], v4, s[32:35], s70 offen
    s_add_u32 s30, s70, 524288
    buffer_load_dwordx4 v[52:55], v4, s[32:35], s30 offen
    s_add_u32 s30, s70, 1048576
    buffer_load_dwordx4 v[56:59], v4, s[32:35], s30 offen
    s_add_u32 s30, s70, 1572864
    buffer_load_dwordx4 v[60:63], v4, s[32:35], s30 offen
    s_add_u32 s74, s74, 1
    s_add_u32 m0, s67, 40960
    s_add_u32 s76, s71, 15360
    buffer_load_dwordx4 v24, s[36:39], s71 offen lds
    buffer_load_dwordx4 v24, s[36:39], s76 offen offset:1024 lds
    s_add_u32 m0, s68, 40960
    s_nop 0
    buffer_load_dwordx4 v25, s[40:43], s71 offen lds
    buffer_load_dwordx4 v25, s[40:43], s76 offen offset:1024 lds
    s_add_u32 m0, s69, 40960
    s_and_b32 s74, s74, 7
    buffer_load_dwordx4 v26, s[84:87], s75 offen lds
    s_lshl_b32 s70, s74, 7
    s_lshl_b32 s71, s74, 16
    s_mul_i32 s75, s74, 176128
    s_waitcnt vmcnt(9)
    v_add_u32 v7, 0, v5
    v_add_u32 v2, 0, v6
    v_perm_b32 v16, v33, v32, v30
    v_perm_b32 v17, v35, v34, v30
    v_perm_b32 v18, v33, v32, v31
    v_perm_b32 v19, v35, v34, v31
    ds_write_b64 v7, v[16:17] offset:0
    ds_write_b64 v2, v[18:19] offset:0
    v_perm_b32 v20, v37, v36, v30
    v_perm_b32 v21, v39, v38, v30
    v_perm_b32 v22, v37, v36, v31
    v_perm_b32 v23, v39, v38, v31
    ds_write_b64 v2, v[20:21] offset:1024
    ds_write_b64 v7, v[22:23] offset:1024
    v_perm_b32 v16, v41, v40, v30
    v_perm_b32 v17, v43, v42, v30
    v_perm_b32 v18, v41, v40, v31
    v_perm_b32 v19, v43, v42, v31
    ds_write_b64 v7, v[16:17] offset:2048
    ds_write_b64 v2, v[18:19] offset:2048
    v_perm_b32 v20, v45, v44, v30
    v_perm_b32 v21, v47, v46, v30
    v_perm_b32 v22, v45, v44, v31
    v_perm_b32 v23, v47, v46, v31
    ds_write_b64 v2, v[20:21] offset:3072
    ds_write_b64 v7, v[22:23] offset:3072
    s_cmp_lg_u32 s59, 0
    s_cbranch_scc1 P1_NP0
    v_add_u32 v7, 0, v27
    s_mov_b64 exec, 0xffff
    ds_write_b16 v7, v28
    s_mov_b64 exec, -1
P1_NP0:
    s_waitcnt lgkmcnt(0)
    s_barrier
    buffer_load_dwordx4 v[32:35], v4, s[32:35], s70 offen
    s_add_u32 s30, s70, 524288
    buffer_load_dwordx4 v[36:39], v4, s[32:35], s30 offen
    s_add_u32 s30, s70, 1048576
    buffer_load_dwordx4 v[40:43], v4, s[32:35], s30 offen
    s_add_u32 s30, s70, 1572864
    buffer_load_dwordx4 v[44:47], v4, s[32:35], s30 offen
    s_add_u32 s74, s74, 1
    s_add_u32 m0, s67, 81920
    s_add_u32 s76, s71, 15360
    buffer_load_dwordx4 v24, s[36:39], s71 offen lds
    buffer_load_dwordx4 v24, s[36:39], s76 offen offset:1024 lds
    s_add_u32 m0, s68, 81920
    s_nop 0
    buffer_load_dwordx4 v25, s[40:43], s71 offen lds
    buffer_load_dwordx4 v25, s[40:43], s76 offen offset:1024 lds
    s_add_u32 m0, s69, 81920
    s_and_b32 s74, s74, 7
    buffer_load_dwordx4 v26, s[84:87], s75 offen lds
    s_lshl_b32 s70, s74, 7
    s_lshl_b32 s71, s74, 16
    s_mul_i32 s75, s74, 176128
    s_waitcnt vmcnt(9)
    v_add_u32 v7, 40960, v5
    v_add_u32 v2, 40960, v6
    v_perm_b32 v16, v49, v48, v30
    v_perm_b32 v17, v51, v50, v30
    v_perm_b32 v18, v49, v48, v31
    v_perm_b32 v19, v51, v50, v31
    ds_write_b64 v7, v[16:17] offset:0
    ds_write_b64 v2, v[18:19] offset:0
    v_perm_b32 v20, v53, v52, v30
    v_perm_b32 v21, v55, v54, v30
    v_perm_b32 v22, v53, v52, v31
    v_perm_b32 v23, v55, v54, v31
    ds_write_b64 v2, v[20:21] offset:1024
    ds_write_b64 v7, v[22:23] offset:1024
    v_perm_b32 v16, v57, v56, v30
    v_perm_b32 v17, v59, v58, v30
    v_perm_b32 v18, v57, v56, v31
    v_perm_b32 v19, v59, v58, v31
    ds_write_b64 v7, v[16:17] offset:2048
    ds_write_b64 v2, v[18:19] offset:2048
    v_perm_b32 v20, v61, v60, v30
    v_perm_b32 v21, v63, v62, v30
    v_perm_b32 v22, v61, v60, v31
    v_perm_b32 v23, v63, v62, v31
    ds_write_b64 v2, v[20:21] offset:3072
    ds_write_b64 v7, v[22:23] offset:3072
    s_cmp_lg_u32 s59, 0
    s_cbranch_scc1 P1_NP1
    v_add_u32 v7, 40960, v27
    s_mov_b64 exec, 0xffff
    ds_write_b16 v7, v28
    s_mov_b64 exec, -1
P1_NP1:
    s_waitcnt lgkmcnt(0)
    s_barrier
    buffer_load_dwordx4 v[48:51], v4, s[32:35], s70 offen
    s_add_u32 s30, s70, 524288
    buffer_load_dwordx4 v[52:55], v4, s[32:35], s30 offen
    s_add_u32 s30, s70, 1048576
    buffer_load_dwordx4 v[56:59], v4, s[32:35], s30 offen
    s_add_u32 s30, s70, 1572864
    buffer_load_dwordx4 v[60:63], v4, s[32:35], s30 offen
    s_add_u32 s74, s74, 1
    s_add_u32 m0, s67, 122880
    s_add_u32 s76, s71, 15360
    buffer_load_dwordx4 v24, s[36:39], s71 offen lds
    buffer_load_dwordx4 v24, s[36:39], s76 offen offset:1024 lds
    s_add_u32 m0, s68, 122880
    s_nop 0
    buffer_load_dwordx4 v25, s[40:43], s71 offen lds
    buffer_load_dwordx4 v25, s[40:43], s76 offen offset:1024 lds
    s_add_u32 m0, s69, 122880
    s_and_b32 s74, s74, 7
    buffer_load_dwordx4 v26, s[84:87], s75 offen lds
    s_lshl_b32 s70, s74, 7
    s_lshl_b32 s71, s74, 16
    s_mul_i32 s75, s74, 176128
    s_waitcnt vmcnt(9)
    v_add_u32 v7, 81920, v5
    v_add_u32 v2, 81920, v6
    v_perm_b32 v16, v33, v32, v30
    v_perm_b32 v17, v35, v34, v30
    v_perm_b32 v18, v33, v32, v31
    v_perm_b32 v19, v35, v34, v31
    ds_write_b64 v7, v[16:17] offset:0
    ds_write_b64 v2, v[18:19] offset:0
    v_perm_b32 v20, v37, v36, v30
    v_perm_b32 v21, v39, v38, v30
    v_perm_b32 v22, v37, v36, v31
    v_perm_b32 v23, v39, v38, v31
    ds_write_b64 v2, v[20:21] offset:1024
    ds_write_b64 v7, v[22:23] offset:1024
    v_perm_b32 v16, v41, v40, v30
    v_perm_b32 v17, v43, v42, v30
    v_perm_b32 v18, v41, v40, v31
    v_perm_b32 v19, v43, v42, v31
    ds_write_b64 v7, v[16:17] offset:2048
    ds_write_b64 v2, v[18:19] offset:2048
    v_perm_b32 v20, v45, v44, v30
    v_perm_b32 v21, v47, v46, v30
    v_perm_b32 v22, v45, v44, v31
    v_perm_b32 v23, v47, v46, v31
    ds_write_b64 v2, v[20:21] offset:3072
    ds_write_b64 v7, v[22:23] offset:3072
    s_cmp_lg_u32 s59, 0
    s_cbranch_scc1 P1_NP2
    v_add_u32 v7, 81920, v27
    s_mov_b64 exec, 0xffff
    ds_write_b16 v7, v28
    s_mov_b64 exec, -1
P1_NP2:
    s_waitcnt lgkmcnt(0)
    s_barrier
    buffer_load_dwordx4 v[32:35], v4, s[32:35], s70 offen
    s_add_u32 s30, s70, 524288
    buffer_load_dwordx4 v[36:39], v4, s[32:35], s30 offen
    s_add_u32 s30, s70, 1048576
    buffer_load_dwordx4 v[40:43], v4, s[32:35], s30 offen
    s_add_u32 s30, s70, 1572864
    buffer_load_dwordx4 v[44:47], v4, s[32:35], s30 offen
    s_add_u32 s74, s74, 1
    s_add_u32 m0, s69, 0
    s_and_b32 s74, s74, 7
    buffer_load_dwordx4 v26, s[84:87], s75 offen lds
    s_lshl_b32 s70, s74, 7
    s_lshl_b32 s71, s74, 16
    s_mul_i32 s75, s74, 176128
    s_waitcnt vmcnt(5)
    v_add_u32 v7, 122880, v5
    v_add_u32 v2, 122880, v6
    v_perm_b32 v16, v49, v48, v30
    v_perm_b32 v17, v51, v50, v30
    v_perm_b32 v18, v49, v48, v31
    v_perm_b32 v19, v51, v50, v31
    ds_write_b64 v7, v[16:17] offset:0
    ds_write_b64 v2, v[18:19] offset:0
    v_perm_b32 v20, v53, v52, v30
    v_perm_b32 v21, v55, v54, v30
    v_perm_b32 v22, v53, v52, v31
    v_perm_b32 v23, v55, v54, v31
    ds_write_b64 v2, v[20:21] offset:1024
    ds_write_b64 v7, v[22:23] offset:1024
    v_perm_b32 v16, v57, v56, v30
    v_perm_b32 v17, v59, v58, v30
    v_perm_b32 v18, v57, v56, v31
    v_perm_b32 v19, v59, v58, v31
    ds_write_b64 v7, v[16:17] offset:2048
    ds_write_b64 v2, v[18:19] offset:2048
    v_perm_b32 v20, v61, v60, v30
    v_perm_b32 v21, v63, v62, v30
    v_perm_b32 v22, v61, v60, v31
    v_perm_b32 v23, v63, v62, v31
    ds_write_b64 v2, v[20:21] offset:3072
    ds_write_b64 v7, v[22:23] offset:3072
    s_cmp_lg_u32 s59, 0
    s_cbranch_scc1 P1_NP3
    v_add_u32 v7, 122880, v27
    s_mov_b64 exec, 0xffff
    ds_write_b16 v7, v28
    s_mov_b64 exec, -1
P1_NP3:
    s_waitcnt lgkmcnt(0)
    s_barrier
    buffer_load_dwordx4 v[48:51], v4, s[32:35], s70 offen
    s_add_u32 s30, s70, 524288
    buffer_load_dwordx4 v[52:55], v4, s[32:35], s30 offen
    s_add_u32 s30, s70, 1048576
    buffer_load_dwordx4 v[56:59], v4, s[32:35], s30 offen
    s_add_u32 s30, s70, 1572864
    buffer_load_dwordx4 v[60:63], v4, s[32:35], s30 offen
    s_add_u32 s74, s74, 1
    s_add_u32 m0, s69, 40960
    s_and_b32 s74, s74, 7
    buffer_load_dwordx4 v26, s[84:87], s75 offen lds
    s_lshl_b32 s70, s74, 7
    s_lshl_b32 s71, s74, 16
    s_mul_i32 s75, s74, 176128
    s_waitcnt vmcnt(5)
    v_add_u32 v7, 0, v5
    v_add_u32 v2, 0, v6
    v_perm_b32 v16, v33, v32, v30
    v_perm_b32 v17, v35, v34, v30
    v_perm_b32 v18, v33, v32, v31
    v_perm_b32 v19, v35, v34, v31
    ds_write_b64 v7, v[16:17] offset:0
    ds_write_b64 v2, v[18:19] offset:0
    v_perm_b32 v20, v37, v36, v30
    v_perm_b32 v21, v39, v38, v30
    v_perm_b32 v22, v37, v36, v31
    v_perm_b32 v23, v39, v38, v31
    ds_write_b64 v2, v[20:21] offset:1024
    ds_write_b64 v7, v[22:23] offset:1024
    v_perm_b32 v16, v41, v40, v30
    v_perm_b32 v17, v43, v42, v30
    v_perm_b32 v18, v41, v40, v31
    v_perm_b32 v19, v43, v42, v31
    ds_write_b64 v7, v[16:17] offset:2048
    ds_write_b64 v2, v[18:19] offset:2048
    v_perm_b32 v20, v45, v44, v30
    v_perm_b32 v21, v47, v46, v30
    v_perm_b32 v22, v45, v44, v31
    v_perm_b32 v23, v47, v46, v31
    ds_write_b64 v2, v[20:21] offset:3072
    ds_write_b64 v7, v[22:23] offset:3072
    s_waitcnt lgkmcnt(0)
    s_barrier
    buffer_load_dwordx4 v[32:35], v4, s[32:35], s70 offen
    s_add_u32 s30, s70, 524288
    buffer_load_dwordx4 v[36:39], v4, s[32:35], s30 offen
    s_add_u32 s30, s70, 1048576
    buffer_load_dwordx4 v[40:43], v4, s[32:35], s30 offen
    s_add_u32 s30, s70, 1572864
    buffer_load_dwordx4 v[44:47], v4, s[32:35], s30 offen
    s_add_u32 s74, s74, 1
    s_add_u32 m0, s69, 81920
    s_and_b32 s74, s74, 7
    buffer_load_dwordx4 v26, s[84:87], s75 offen lds
    s_lshl_b32 s70, s74, 7
    s_lshl_b32 s71, s74, 16
    s_mul_i32 s75, s74, 176128
    s_waitcnt vmcnt(5)
    v_add_u32 v7, 40960, v5
    v_add_u32 v2, 40960, v6
    v_perm_b32 v16, v49, v48, v30
    v_perm_b32 v17, v51, v50, v30
    v_perm_b32 v18, v49, v48, v31
    v_perm_b32 v19, v51, v50, v31
    ds_write_b64 v7, v[16:17] offset:0
    ds_write_b64 v2, v[18:19] offset:0
    v_perm_b32 v20, v53, v52, v30
    v_perm_b32 v21, v55, v54, v30
    v_perm_b32 v22, v53, v52, v31
    v_perm_b32 v23, v55, v54, v31
    ds_write_b64 v2, v[20:21] offset:1024
    ds_write_b64 v7, v[22:23] offset:1024
    v_perm_b32 v16, v57, v56, v30
    v_perm_b32 v17, v59, v58, v30
    v_perm_b32 v18, v57, v56, v31
    v_perm_b32 v19, v59, v58, v31
    ds_write_b64 v7, v[16:17] offset:2048
    ds_write_b64 v2, v[18:19] offset:2048
    v_perm_b32 v20, v61, v60, v30
    v_perm_b32 v21, v63, v62, v30
    v_perm_b32 v22, v61, v60, v31
    v_perm_b32 v23, v63, v62, v31
    ds_write_b64 v2, v[20:21] offset:3072
    ds_write_b64 v7, v[22:23] offset:3072
    s_waitcnt lgkmcnt(0)
    s_barrier
    buffer_load_dwordx4 v[48:51], v4, s[32:35], s70 offen
    s_add_u32 s30, s70, 524288
    buffer_load_dwordx4 v[52:55], v4, s[32:35], s30 offen
    s_add_u32 s30, s70, 1048576
    buffer_load_dwordx4 v[56:59], v4, s[32:35], s30 offen
    s_add_u32 s30, s70, 1572864
    buffer_load_dwordx4 v[60:63], v4, s[32:35], s30 offen
    s_add_u32 s74, s74, 1
    s_add_u32 m0, s69, 122880
    s_and_b32 s74, s74, 7
    buffer_load_dwordx4 v26, s[84:87], s75 offen lds
    s_lshl_b32 s70, s74, 7
    s_lshl_b32 s71, s74, 16
    s_mul_i32 s75, s74, 176128
    s_waitcnt vmcnt(5)
    v_add_u32 v7, 81920, v5
    v_add_u32 v2, 81920, v6
    v_perm_b32 v16, v33, v32, v30
    v_perm_b32 v17, v35, v34, v30
    v_perm_b32 v18, v33, v32, v31
    v_perm_b32 v19, v35, v34, v31
    ds_write_b64 v7, v[16:17] offset:0
    ds_write_b64 v2, v[18:19] offset:0
    v_perm_b32 v20, v37, v36, v30
    v_perm_b32 v21, v39, v38, v30
    v_perm_b32 v22, v37, v36, v31
    v_perm_b32 v23, v39, v38, v31
    ds_write_b64 v2, v[20:21] offset:1024
    ds_write_b64 v7, v[22:23] offset:1024
    v_perm_b32 v16, v41, v40, v30
    v_perm_b32 v17, v43, v42, v30
    v_perm_b32 v18, v41, v40, v31
    v_perm_b32 v19, v43, v42, v31
    ds_write_b64 v7, v[16:17] offset:2048
    ds_write_b64 v2, v[18:19] offset:2048
    v_perm_b32 v20, v45, v44, v30
    v_perm_b32 v21, v47, v46, v30
    v_perm_b32 v22, v45, v44, v31
    v_perm_b32 v23, v47, v46, v31
    ds_write_b64 v2, v[20:21] offset:3072
    ds_write_b64 v7, v[22:23] offset:3072
    s_waitcnt lgkmcnt(0)
    s_barrier
    s_lshr_b32 s30, s2, 3
    s_lshl_b32 s30, s30, 2
    s_add_u32 s30, s30, s3
    s_mul_i32 s30, s30, 11264
    v_lshlrev_b32 v12, 10, v0
    s_mov_b64 exec, 0x7ff
    buffer_load_dword v82, v12, s[52:55], s30 offen offset:384
    s_mov_b64 exec, -1
    s_add_u32 m0, s77, 0
    s_lshl_b32 s30, s65, 14
    s_add_u32 s31, s30, 7168
    buffer_load_dwordx4 v29, s[52:55], s30 offen lds
    s_add_u32 s65, s65, 1
    s_cmp_eq_u32 s65, 22
    s_cselect_b32 s65, 0, s65
    buffer_load_dwordx4 v29, s[52:55], s31 offen offset:1024 lds
    s_add_u32 m0, s77, 2048
    s_lshl_b32 s30, s65, 14
    s_add_u32 s31, s30, 7168
    buffer_load_dwordx4 v29, s[52:55], s30 offen lds
    s_add_u32 s65, s65, 1
    s_cmp_eq_u32 s65, 22
    s_cselect_b32 s65, 0, s65
    buffer_load_dwordx4 v29, s[52:55], s31 offen offset:1024 lds
    s_add_u32 m0, s77, 4096
    s_lshl_b32 s30, s65, 14
    s_add_u32 s31, s30, 7168
    buffer_load_dwordx4 v29, s[52:55], s30 offen lds
    s_add_u32 s65, s65, 1
    s_cmp_eq_u32 s65, 22
    s_cselect_b32 s65, 0, s65
    buffer_load_dwordx4 v29, s[52:55], s31 offen offset:1024 lds
    s_add_u32 m0, s77, 6144
    s_lshl_b32 s30, s65, 14
    s_add_u32 s31, s30, 7168
    buffer_load_dwordx4 v29, s[52:55], s30 offen lds
    s_add_u32 s65, s65, 1
    s_cmp_eq_u32 s65, 22
    s_cselect_b32 s65, 0, s65
    buffer_load_dwordx4 v29, s[52:55], s31 offen offset:1024 lds
    s_waitcnt vmcnt(9)
    v_add_u32 v7, 122880, v5
    v_add_u32 v2, 122880, v6
    v_perm_b32 v16, v49, v48, v30
    v_perm_b32 v17, v51, v50, v30
    v_perm_b32 v18, v49, v48, v31
    v_perm_b32 v19, v51, v50, v31
    ds_write_b64 v7, v[16:17] offset:0
    ds_write_b64 v2, v[18:19] offset:0
    v_perm_b32 v20, v53, v52, v30
    v_perm_b32 v21, v55, v54, v30
    v_perm_b32 v22, v53, v52, v31
    v_perm_b32 v23, v55, v54, v31
    ds_write_b64 v2, v[20:21] offset:1024
    ds_write_b64 v7, v[22:23] offset:1024
    v_perm_b32 v16, v57, v56, v30
    v_perm_b32 v17, v59, v58, v30
    v_perm_b32 v18, v57, v56, v31
    v_perm_b32 v19, v59, v58, v31
    ds_write_b64 v7, v[16:17] offset:2048
    ds_write_b64 v2, v[18:19] offset:2048
    v_perm_b32 v20, v61, v60, v30
    v_perm_b32 v21, v63, v62, v30
    v_perm_b32 v22, v61, v60, v31
    v_perm_b32 v23, v63, v62, v31
    ds_write_b64 v2, v[20:21] offset:3072
    ds_write_b64 v7, v[22:23] offset:3072
    s_waitcnt lgkmcnt(0)
    s_barrier
    s_load_dwordx8 s[4:11], s[26:27], 0
    s_add_u32 m0, s77, 8192
    s_lshl_b32 s30, s65, 14
    s_add_u32 s31, s30, 7168
    buffer_load_dwordx4 v29, s[52:55], s30 offen lds
    s_add_u32 s65, s65, 1
    s_cmp_eq_u32 s65, 22
    s_cselect_b32 s65, 0, s65
    buffer_load_dwordx4 v29, s[52:55], s31 offen offset:1024 lds
    s_add_u32 m0, s77, 40960
    s_lshl_b32 s30, s65, 14
    s_add_u32 s31, s30, 7168
    buffer_load_dwordx4 v29, s[52:55], s30 offen lds
    s_add_u32 s65, s65, 1
    s_cmp_eq_u32 s65, 22
    s_cselect_b32 s65, 0, s65
    buffer_load_dwordx4 v29, s[52:55], s31 offen offset:1024 lds
    s_add_u32 m0, s77, 43008
    s_lshl_b32 s30, s65, 14
    s_add_u32 s31, s30, 7168
    buffer_load_dwordx4 v29, s[52:55], s30 offen lds
    s_add_u32 s65, s65, 1
    s_cmp_eq_u32 s65, 22
    s_cselect_b32 s65, 0, s65
    buffer_load_dwordx4 v29, s[52:55], s31 offen offset:1024 lds
    s_add_u32 m0, s77, 45056
    s_lshl_b32 s30, s65, 14
    s_add_u32 s31, s30, 7168
    buffer_load_dwordx4 v29, s[52:55], s30 offen lds
    s_add_u32 s65, s65, 1
    s_cmp_eq_u32 s65, 22
    s_cselect_b32 s65, 0, s65
    buffer_load_dwordx4 v29, s[52:55], s31 offen offset:1024 lds
    s_waitcnt lgkmcnt(0)
    s_and_b64 s[4:5], s[4:5], s[6:7]
    s_and_b64 s[8:9], s[8:9], s[10:11]
    s_and_b64 s[4:5], s[4:5], s[8:9]
    s_and_b32 s4, s4, s5
    s_cbranch_scc1 NOKLS
    s_mov_b32 s48, s26
    s_mov_b32 s49, s27
    s_mov_b32 s50, 0x100
    s_mov_b32 s51, 0x20000
    s_mov_b32 s61, 0
    v_lshlrev_b32 v31, 2, v0
    s_mov_b64 exec, 0xff
NLLS:
    v_mov_b32 v30, 0
    buffer_atomic_add v30, v31, s[48:51], 0 offen sc0 sc1
    s_add_u32 s61, s61, 1
    s_cmp_gt_u32 s61, 400000
    s_waitcnt vmcnt(0)
    s_cbranch_scc1 NXLS
    v_cmp_eq_u32 vcc, 0, v30
    s_cbranch_vccnz NLLS
NXLS:
    s_mov_b64 exec, -1
NOKLS:
    s_barrier
    s_branch P2_W8
P2_W4:
    s_add_u32 m0, s77, 8192
    s_lshl_b32 s30, s65, 14
    s_add_u32 s31, s30, 7168
    buffer_load_dwordx4 v29, s[52:55], s30 offen lds
    s_add_u32 s65, s65, 1
    s_cmp_eq_u32 s65, 22
    s_cselect_b32 s65, 0, s65
    buffer_load_dwordx4 v29, s[52:55], s31 offen offset:1024 lds
P2_W5:
    s_add_u32 m0, s77, 40960
    s_lshl_b32 s30, s65, 14
    s_add_u32 s31, s30, 7168
    buffer_load_dwordx4 v29, s[52:55], s30 offen lds
    s_add_u32 s65, s65, 1
    s_cmp_eq_u32 s65, 22
    s_cselect_b32 s65, 0, s65
    buffer_load_dwordx4 v29, s[52:55], s31 offen offset:1024 lds
P2_W6:
    s_and_b32 s76, s57, 7
    s_cmp_lg_u32 s76, 1
    s_cbranch_scc1 NOG2A
    s_sub_u32 s73, s57, 1
    s_mov_b32 s48, s22
    s_mov_b32 s49, s23
    s_mov_b32 s50, 0x400
    s_mov_b32 s51, 0x20000
    s_lshl_b32 s30, s73, 3
    s_lshl_b32 s31, s3, 1
    s_add_u32 s30, s30, s31
    s_lshr_b32 s31, s30, 5
    s_and_b32 s30, s30, 31
    s_lshl_b32 s30, s30, 6
    s_add_u32 s30, s30, s31
    s_lshl_b32 s31, s56, 2
    s_add_u32 s64, s30, s31
    s_lshl_b32 s30, s64, 10
    s_add_u32 s31, s30, 0x10000
    v_lshlrev_b32 v12, 4, v0
    buffer_load_dwordx4 v[84:87], v12, s[32:35], s30 offen
    buffer_load_dwordx4 v[88:91], v12, s[32:35], s31 offen
NOG2A:
    s_mov_b32 s48, s22
    s_mov_b32 s49, s23
    s_mov_b32 s50, 0x400
    s_mov_b32 s51, 0x20000
    s_lshl_b32 s30, s57, 3
    s_lshl_b32 s31, s3, 1
    s_add_u32 s30, s30, s31
    s_lshr_b32 s31, s30, 5
    s_and_b32 s30, s30, 31
    s_lshl_b32 s30, s30, 6
    s_add_u32 s30, s30, s31
    s_lshl_b32 s31, s56, 2
    s_add_u32 s64, s30, s31
    s_lshl_b32 s30, s64, 10
    s_add_u32 s31, s30, 0x10000
    v_lshlrev_b32 v12, 4, v0
    buffer_load_dwordx4 v[64:67], v12, s[48:51], 0 offen
    buffer_load_dwordx4 v[68:71], v12, s[32:35], s30 offen
    buffer_load_dwordx4 v[72:75], v12, s[32:35], s31 offen
    s_add_u32 m0, s77, 43008
    s_lshl_b32 s30, s65, 14
    s_add_u32 s31, s30, 7168
    buffer_load_dwordx4 v29, s[52:55], s30 offen lds
    s_add_u32 s65, s65, 1
    s_cmp_eq_u32 s65, 22
    s_cselect_b32 s65, 0, s65
    buffer_load_dwordx4 v29, s[52:55], s31 offen offset:1024 lds
P2_W7:
    s_add_u32 m0, s77, 45056
    s_lshl_b32 s30, s65, 14
    s_add_u32 s31, s30, 7168
    buffer_load_dwordx4 v29, s[52:55], s30 offen lds
    s_add_u32 s65, s65, 1
    s_cmp_eq_u32 s65, 22
    s_cselect_b32 s65, 0, s65
    buffer_load_dwordx4 v29, s[52:55], s31 offen offset:1024 lds
P2_W8:
    s_add_u32 m0, s77, 47104
    s_lshl_b32 s30, s65, 14
    s_add_u32 s31, s30, 7168
    buffer_load_dwordx4 v29, s[52:55], s30 offen lds
    s_add_u32 s65, s65, 1
    s_cmp_eq_u32 s65, 22
    s_cselect_b32 s65, 0, s65
    buffer_load_dwordx4 v29, s[52:55], s31 offen offset:1024 lds
P2_W9:
    s_add_u32 m0, s77, 49152
    s_lshl_b32 s30, s65, 14
    s_add_u32 s31, s30, 7168
    buffer_load_dwordx4 v29, s[52:55], s30 offen lds
    s_add_u32 s65, s65, 1
    s_cmp_eq_u32 s65, 22
    s_cselect_b32 s65, 0, s65
    buffer_load_dwordx4 v29, s[52:55], s31 offen offset:1024 lds
P2_W10:
    s_add_u32 m0, s77, 81920
    s_lshl_b32 s30, s65, 14
    s_add_u32 s31, s30, 7168
    buffer_load_dwordx4 v29, s[52:55], s30 offen lds
    s_add_u32 s65, s65, 1
    s_cmp_eq_u32 s65, 22
    s_cselect_b32 s65, 0, s65
    buffer_load_dwordx4 v29, s[52:55], s31 offen offset:1024 lds
P2_W11:
    s_add_u32 m0, s77, 83968
    s_lshl_b32 s30, s65, 14
    s_add_u32 s31, s30, 7168
    buffer_load_dwordx4 v29, s[52:55], s30 offen lds
    s_add_u32 s65, s65, 1
    s_cmp_eq_u32 s65, 22
    s_cselect_b32 s65, 0, s65
    buffer_load_dwordx4 v29, s[52:55], s31 offen offset:1024 lds
P2_W12:
    s_add_u32 m0, s77, 86016
    s_lshl_b32 s30, s65, 14
    s_add_u32 s31, s30, 7168
    buffer_load_dwordx4 v29, s[52:55], s30 offen lds
    s_add_u32 s65, s65, 1
    s_cmp_eq_u32 s65, 22
    s_cselect_b32 s65, 0, s65
    buffer_load_dwordx4 v29, s[52:55], s31 offen offset:1024 lds
P2_W13:
    s_add_u32 m0, s77, 88064
    s_lshl_b32 s30, s65, 14
    s_add_u32 s31, s30, 7168
    buffer_load_dwordx4 v29, s[52:55], s30 offen lds
    s_add_u32 s65, s65, 1
    s_cmp_eq_u32 s65, 22
    s_cselect_b32 s65, 0, s65
    buffer_load_dwordx4 v29, s[52:55], s31 offen offset:1024 lds
P2_W14:
    s_add_u32 m0, s77, 90112
    s_lshl_b32 s30, s65, 14
    s_add_u32 s31, s30, 7168
    buffer_load_dwordx4 v29, s[52:55], s30 offen lds
    s_add_u32 s65, s65, 1
    s_cmp_eq_u32 s65, 22
    s_cselect_b32 s65, 0, s65
    buffer_load_dwordx4 v29, s[52:55], s31 offen offset:1024 lds
P2_W15:
    s_add_u32 m0, s77, 122880
    s_lshl_b32 s30, s65, 14
    s_add_u32 s31, s30, 7168
    buffer_load_dwordx4 v29, s[52:55], s30 offen lds
    s_add_u32 s65, s65, 1
    s_cmp_eq_u32 s65, 22
    s_cselect_b32 s65, 0, s65
    buffer_load_dwordx4 v29, s[52:55], s31 offen offset:1024 lds
P2_W16:
    s_add_u32 m0, s77, 124928
    s_lshl_b32 s30, s65, 14
    s_add_u32 s31, s30, 7168
    buffer_load_dwordx4 v29, s[52:55], s30 offen lds
    s_add_u32 s65, s65, 1
    s_cmp_eq_u32 s65, 22
    s_cselect_b32 s65, 0, s65
    buffer_load_dwordx4 v29, s[52:55], s31 offen offset:1024 lds
P2_W17:
    s_add_u32 m0, s77, 126976
    s_lshl_b32 s30, s65, 14
    s_add_u32 s31, s30, 7168
    buffer_load_dwordx4 v29, s[52:55], s30 offen lds
    s_add_u32 s65, s65, 1
    s_cmp_eq_u32 s65, 22
    s_cselect_b32 s65, 0, s65
    buffer_load_dwordx4 v29, s[52:55], s31 offen offset:1024 lds
P2_W18:
    s_add_u32 m0, s77, 129024
    s_lshl_b32 s30, s65, 14
    s_add_u32 s31, s30, 7168
    buffer_load_dwordx4 v29, s[52:55], s30 offen lds
    s_add_u32 s65, s65, 1
    s_cmp_eq_u32 s65, 22
    s_cselect_b32 s65, 0, s65
    buffer_load_dwordx4 v29, s[52:55], s31 offen offset:1024 lds
P2_W19:
    s_add_u32 m0, s77, 131072
    s_lshl_b32 s30, s65, 14
    s_add_u32 s31, s30, 7168
    buffer_load_dwordx4 v29, s[52:55], s30 offen lds
    s_add_u32 s65, s65, 1
    s_cmp_eq_u32 s65, 22
    s_cselect_b32 s65, 0, s65
    buffer_load_dwordx4 v29, s[52:55], s31 offen offset:1024 lds
    s_cmp_eq_u32 s58, 1
    s_cbranch_scc1 NOGC
    s_waitcnt vmcnt(28)
    v_lshlrev_b32 v76, 16, v68
    v_and_b32 v77, 0xffff0000, v68
    v_lshlrev_b32 v78, 16, v64
    v_and_b32 v79, 0xffff0000, v64
    v_mul_f32 v76, v76, v78
    v_mul_f32 v77, v77, v79
    v_cvt_pk_bf16_f32 v76, v76, v77
    v_and_b32 v77, 0xffff0000, v76
    v_lshlrev_b32 v76, 16, v76
    v_add_f32 v80, v76, v77
    v_lshlrev_b32 v76, 16, v69
    v_and_b32 v77, 0xffff0000, v69
    v_lshlrev_b32 v78, 16, v65
    v_and_b32 v79, 0xffff0000, v65
    v_mul_f32 v76, v76, v78
    v_mul_f32 v77, v77, v79
    v_cvt_pk_bf16_f32 v76, v76, v77
    v_and_b32 v77, 0xffff0000, v76
    v_lshlrev_b32 v76, 16, v76
    v_add_f32 v80, v80, v76
    v_add_f32 v80, v80, v77
    v_lshlrev_b32 v76, 16, v70
    v_and_b32 v77, 0xffff0000, v70
    v_lshlrev_b32 v78, 16, v66
    v_and_b32 v79, 0xffff0000, v66
    v_mul_f32 v76, v76, v78
    v_mul_f32 v77, v77, v79
    v_cvt_pk_bf16_f32 v76, v76, v77
    v_and_b32 v77, 0xffff0000, v76
    v_lshlrev_b32 v76, 16, v76
    v_add_f32 v80, v80, v76
    v_add_f32 v80, v80, v77
    v_lshlrev_b32 v76, 16, v71
    v_and_b32 v77, 0xffff0000, v71
    v_lshlrev_b32 v78, 16, v67
    v_and_b32 v79, 0xffff0000, v67
    v_mul_f32 v76, v76, v78
    v_mul_f32 v77, v77, v79
    v_cvt_pk_bf16_f32 v76, v76, v77
    v_and_b32 v77, 0xffff0000, v76
    v_lshlrev_b32 v76, 16, v76
    v_add_f32 v80, v80, v76
    v_add_f32 v80, v80, v77
    v_lshlrev_b32 v76, 16, v72
    v_and_b32 v77, 0xffff0000, v72
    v_lshlrev_b32 v78, 16, v64
    v_and_b32 v79, 0xffff0000, v64
    v_mul_f32 v76, v76, v78
    v_mul_f32 v77, v77, v79
    v_cvt_pk_bf16_f32 v76, v76, v77
    v_and_b32 v77, 0xffff0000, v76
    v_lshlrev_b32 v76, 16, v76
    v_add_f32 v81, v76, v77
    v_lshlrev_b32 v76, 16, v73
    v_and_b32 v77, 0xffff0000, v73
    v_lshlrev_b32 v78, 16, v65
    v_and_b32 v79, 0xffff0000, v65
    v_mul_f32 v76, v76, v78
    v_mul_f32 v77, v77, v79
    v_cvt_pk_bf16_f32 v76, v76, v77
    v_and_b32 v77, 0xffff0000, v76
    v_lshlrev_b32 v76, 16, v76
    v_add_f32 v81, v81, v76
    v_add_f32 v81, v81, v77
    v_lshlrev_b32 v76, 16, v74
    v_and_b32 v77, 0xffff0000, v74
    v_lshlrev_b32 v78, 16, v66
    v_and_b32 v79, 0xffff0000, v66
    v_mul_f32 v76, v76, v78
    v_mul_f32 v77, v77, v79
    v_cvt_pk_bf16_f32 v76, v76, v77
    v_and_b32 v77, 0xffff0000, v76
    v_lshlrev_b32 v76, 16, v76
    v_add_f32 v81, v81, v76
    v_add_f32 v81, v81, v77
    v_lshlrev_b32 v76, 16, v75
    v_and_b32 v77, 0xffff0000, v75
    v_lshlrev_b32 v78, 16, v67
    v_and_b32 v79, 0xffff0000, v67
    v_mul_f32 v76, v76, v78
    v_mul_f32 v77, v77, v79
    v_cvt_pk_bf16_f32 v76, v76, v77
    v_and_b32 v77, 0xffff0000, v76
    v_lshlrev_b32 v76, 16, v76
    v_add_f32 v81, v81, v76
    v_add_f32 v81, v81, v77
    s_nop 1
    v_add_f32_dpp v80, v80, v80 row_ror:8 row_mask:0xf bank_mask:0xf
    v_add_f32_dpp v81, v81, v81 row_ror:8 row_mask:0xf bank_mask:0xf
    s_nop 1
    v_add_f32_dpp v80, v80, v80 row_ror:4 row_mask:0xf bank_mask:0xf
    v_add_f32_dpp v81, v81, v81 row_ror:4 row_mask:0xf bank_mask:0xf
    s_nop 1
    v_add_f32_dpp v80, v80, v80 row_ror:2 row_mask:0xf bank_mask:0xf
    v_add_f32_dpp v81, v81, v81 row_ror:2 row_mask:0xf bank_mask:0xf
    s_nop 1
    v_add_f32_dpp v80, v80, v80 row_ror:1 row_mask:0xf bank_mask:0xf
    v_add_f32_dpp v81, v81, v81 row_ror:1 row_mask:0xf bank_mask:0xf
    s_nop 1
    v_add_f32_dpp v80, v80, v80 row_bcast:15 row_mask:0xa bank_mask:0xf
    v_add_f32_dpp v81, v81, v81 row_bcast:15 row_mask:0xa bank_mask:0xf
    s_nop 1
    v_add_f32_dpp v80, v80, v80 row_bcast:31 row_mask:0xc bank_mask:0xf
    v_add_f32_dpp v81, v81, v81 row_bcast:31 row_mask:0xc bank_mask:0xf
    s_nop 1
    v_cvt_pk_bf16_f32 v80, v80, v81
    v_and_b32 v81, 0xffff0000, v80
    v_lshlrev_b32 v80, 16, v80
    v_mul_f32 v80, 0xbfb8aa3b, v80
    v_mul_f32 v81, 0xbfb8aa3b, v81
    v_exp_f32 v80, v80
    v_exp_f32 v81, v81
    s_nop 0
    v_add_f32 v80, 1.0, v80
    v_add_f32 v81, 1.0, v81
    v_rcp_f32 v80, v80
    v_rcp_f32 v81, v81
    s_nop 0
    v_cvt_pk_bf16_f32 v80, v80, v81
    v_and_b32 v81, 0xffff0000, v80
    v_lshlrev_b32 v80, 16, v80
    s_lshl_b32 s30, s56, 4
    s_add_u32 s30, s30, s57
    s_lshl_b32 s30, s30, 2
    s_add_u32 s30, s30, s3
    s_lshl_b32 s30, s30, 7
    s_add_u32 s30, s30, 0x8e0000
    s_mov_b32 exec_lo, 0
    s_brev_b32 exec_hi, 1
    buffer_store_dwordx2 v[80:81], off, s[44:47], s30 sc1
    s_mov_b64 exec, -1
    s_cmp_lg_u32 s76, 1
    s_cbranch_scc1 NOGC
    v_lshlrev_b32 v76, 16, v84
    v_and_b32 v77, 0xffff0000, v84
    v_lshlrev_b32 v78, 16, v64
    v_and_b32 v79, 0xffff0000, v64
    v_mul_f32 v76, v76, v78
    v_mul_f32 v77, v77, v79
    v_cvt_pk_bf16_f32 v76, v76, v77
    v_and_b32 v77, 0xffff0000, v76
    v_lshlrev_b32 v76, 16, v76
    v_add_f32 v80, v76, v77
    v_lshlrev_b32 v76, 16, v85
    v_and_b32 v77, 0xffff0000, v85
    v_lshlrev_b32 v78, 16, v65
    v_and_b32 v79, 0xffff0000, v65
    v_mul_f32 v76, v76, v78
    v_mul_f32 v77, v77, v79
    v_cvt_pk_bf16_f32 v76, v76, v77
    v_and_b32 v77, 0xffff0000, v76
    v_lshlrev_b32 v76, 16, v76
    v_add_f32 v80, v80, v76
    v_add_f32 v80, v80, v77
    v_lshlrev_b32 v76, 16, v86
    v_and_b32 v77, 0xffff0000, v86
    v_lshlrev_b32 v78, 16, v66
    v_and_b32 v79, 0xffff0000, v66
    v_mul_f32 v76, v76, v78
    v_mul_f32 v77, v77, v79
    v_cvt_pk_bf16_f32 v76, v76, v77
    v_and_b32 v77, 0xffff0000, v76
    v_lshlrev_b32 v76, 16, v76
    v_add_f32 v80, v80, v76
    v_add_f32 v80, v80, v77
    v_lshlrev_b32 v76, 16, v87
    v_and_b32 v77, 0xffff0000, v87
    v_lshlrev_b32 v78, 16, v67
    v_and_b32 v79, 0xffff0000, v67
    v_mul_f32 v76, v76, v78
    v_mul_f32 v77, v77, v79
    v_cvt_pk_bf16_f32 v76, v76, v77
    v_and_b32 v77, 0xffff0000, v76
    v_lshlrev_b32 v76, 16, v76
    v_add_f32 v80, v80, v76
    v_add_f32 v80, v80, v77
    v_lshlrev_b32 v76, 16, v88
    v_and_b32 v77, 0xffff0000, v88
    v_lshlrev_b32 v78, 16, v64
    v_and_b32 v79, 0xffff0000, v64
    v_mul_f32 v76, v76, v78
    v_mul_f32 v77, v77, v79
    v_cvt_pk_bf16_f32 v76, v76, v77
    v_and_b32 v77, 0xffff0000, v76
    v_lshlrev_b32 v76, 16, v76
    v_add_f32 v81, v76, v77
    v_lshlrev_b32 v76, 16, v89
    v_and_b32 v77, 0xffff0000, v89
    v_lshlrev_b32 v78, 16, v65
    v_and_b32 v79, 0xffff0000, v65
    v_mul_f32 v76, v76, v78
    v_mul_f32 v77, v77, v79
    v_cvt_pk_bf16_f32 v76, v76, v77
    v_and_b32 v77, 0xffff0000, v76
    v_lshlrev_b32 v76, 16, v76
    v_add_f32 v81, v81, v76
    v_add_f32 v81, v81, v77
    v_lshlrev_b32 v76, 16, v90
    v_and_b32 v77, 0xffff0000, v90
    v_lshlrev_b32 v78, 16, v66
    v_and_b32 v79, 0xffff0000, v66
    v_mul_f32 v76, v76, v78
    v_mul_f32 v77, v77, v79
    v_cvt_pk_bf16_f32 v76, v76, v77
    v_and_b32 v77, 0xffff0000, v76
    v_lshlrev_b32 v76, 16, v76
    v_add_f32 v81, v81, v76
    v_add_f32 v81, v81, v77
    v_lshlrev_b32 v76, 16, v91
    v_and_b32 v77, 0xffff0000, v91
    v_lshlrev_b32 v78, 16, v67
    v_and_b32 v79, 0xffff0000, v67
    v_mul_f32 v76, v76, v78
    v_mul_f32 v77, v77, v79
    v_cvt_pk_bf16_f32 v76, v76, v77
    v_and_b32 v77, 0xffff0000, v76
    v_lshlrev_b32 v76, 16, v76
    v_add_f32 v81, v81, v76
    v_add_f32 v81, v81, v77
    s_nop 1
    v_add_f32_dpp v80, v80, v80 row_ror:8 row_mask:0xf bank_mask:0xf
    v_add_f32_dpp v81, v81, v81 row_ror:8 row_mask:0xf bank_mask:0xf
    s_nop 1
    v_add_f32_dpp v80, v80, v80 row_ror:4 row_mask:0xf bank_mask:0xf
    v_add_f32_dpp v81, v81, v81 row_ror:4 row_mask:0xf bank_mask:0xf
    s_nop 1
    v_add_f32_dpp v80, v80, v80 row_ror:2 row_mask:0xf bank_mask:0xf
    v_add_f32_dpp v81, v81, v81 row_ror:2 row_mask:0xf bank_mask:0xf
    s_nop 1
    v_add_f32_dpp v80, v80, v80 row_ror:1 row_mask:0xf bank_mask:0xf
    v_add_f32_dpp v81, v81, v81 row_ror:1 row_mask:0xf bank_mask:0xf
    s_nop 1
    v_add_f32_dpp v80, v80, v80 row_bcast:15 row_mask:0xa bank_mask:0xf
    v_add_f32_dpp v81, v81, v81 row_bcast:15 row_mask:0xa bank_mask:0xf
    s_nop 1
    v_add_f32_dpp v80, v80, v80 row_bcast:31 row_mask:0xc bank_mask:0xf
    v_add_f32_dpp v81, v81, v81 row_bcast:31 row_mask:0xc bank_mask:0xf
    s_nop 1
    v_cvt_pk_bf16_f32 v80, v80, v81
    v_and_b32 v81, 0xffff0000, v80
    v_lshlrev_b32 v80, 16, v80
    v_mul_f32 v80, 0xbfb8aa3b, v80
    v_mul_f32 v81, 0xbfb8aa3b, v81
    v_exp_f32 v80, v80
    v_exp_f32 v81, v81
    s_nop 0
    v_add_f32 v80, 1.0, v80
    v_add_f32 v81, 1.0, v81
    v_rcp_f32 v80, v80
    v_rcp_f32 v81, v81
    s_nop 0
    v_cvt_pk_bf16_f32 v80, v80, v81
    v_and_b32 v81, 0xffff0000, v80
    v_lshlrev_b32 v80, 16, v80
    s_lshl_b32 s30, s56, 4
    s_add_u32 s30, s30, s73
    s_lshl_b32 s30, s30, 2
    s_add_u32 s30, s30, s3
    s_lshl_b32 s30, s30, 7
    s_add_u32 s30, s30, 0x8e0000
    s_mov_b32 exec_lo, 0
    s_brev_b32 exec_hi, 1
    buffer_store_dwordx2 v[80:81], off, s[44:47], s30 sc1
    s_mov_b64 exec, -1
NOGC:
    s_and_b32 s75, s57, 7
    s_cmp_eq_u32 s75, 1
    s_cselect_b32 s30, 2, 1
    s_cmp_eq_u32 s75, 0
    s_cselect_b32 s75, 0, s30
    s_waitcnt vmcnt(20)
    ds_read_b64_tr_b16 v[96:97], v226 offset:0
    ds_read_b64_tr_b16 v[98:99], v226 offset:512
    ds_read_b64_tr_b16 v[100:101], v227 offset:0
    ds_read_b64_tr_b16 v[102:103], v227 offset:512
    ds_read_b64_tr_b16 v[104:105], v226 offset:2048
    ds_read_b64_tr_b16 v[106:107], v226 offset:2560
    ds_read_b64_tr_b16 v[108:109], v227 offset:2048
    ds_read_b64_tr_b16 v[110:111], v227 offset:2560
    s_waitcnt lgkmcnt(0)
    s_add_u32 m0, s77, 0
    s_lshl_b32 s30, s65, 14
    s_add_u32 s31, s30, 7168
    buffer_load_dwordx4 v29, s[52:55], s30 offen lds
    s_add_u32 s65, s65, 1
    s_cmp_eq_u32 s65, 22
    s_cselect_b32 s65, 0, s65
    buffer_load_dwordx4 v29, s[52:55], s31 offen offset:1024 lds
    s_add_u32 m0, s77, 2048
    s_lshl_b32 s30, s65, 14
    s_add_u32 s31, s30, 7168
    buffer_load_dwordx4 v29, s[52:55], s30 offen lds
    s_add_u32 s65, s65, 1
    s_cmp_eq_u32 s65, 22
    s_cselect_b32 s65, 0, s65
    buffer_load_dwordx4 v29, s[52:55], s31 offen offset:1024 lds
    s_mov_b32 s30, 0x910000
    s_mov_b32 s61, 0
    s_mov_b32 exec_lo, 0x1
    s_mov_b32 exec_hi, 0x0
PLL:
    v_mov_b32 v22, 0
    buffer_atomic_add v22, v230, s[44:47], s30 offen sc0 sc1
    s_add_u32 s61, s61, 1
    s_cmp_gt_u32 s61, 400000
    s_waitcnt vmcnt(0)
    s_cbranch_scc1 PDL
    v_cmp_ne_u32 vcc, v22, v231
    s_cbranch_vccnz PLL
PDL:
    s_mov_b64 exec, -1
    s_mov_b32 s64, s94
    s_lshl_b32 s30, s64, 10
    s_cmp_ge_u32 s64, s72
    s_cselect_b32 s30, 0x10000000, s30
    s_add_u32 s64, s64, 1
    buffer_load_dwordx4 v[32:35], v224, s[44:47], s30 offen sc1
    s_cmp_eq_u32 s64, 22
    s_cselect_b32 s64, 0, s64
    buffer_load_dwordx4 v[36:39], v225, s[44:47], s30 offen sc1
    s_lshl_b32 s30, s64, 10
    s_cmp_ge_u32 s64, s72
    s_cselect_b32 s30, 0x10000000, s30
    s_add_u32 s64, s64, 1
    buffer_load_dwordx4 v[40:43], v224, s[44:47], s30 offen sc1
    s_cmp_eq_u32 s64, 22
    s_cselect_b32 s64, 0, s64
    buffer_load_dwordx4 v[44:47], v225, s[44:47], s30 offen sc1
    s_lshl_b32 s30, s64, 10
    s_cmp_ge_u32 s64, s72
    s_cselect_b32 s30, 0x10000000, s30
    s_add_u32 s64, s64, 1
    buffer_load_dwordx4 v[48:51], v224, s[44:47], s30 offen sc1
    s_cmp_eq_u32 s64, 22
    s_cselect_b32 s64, 0, s64
    buffer_load_dwordx4 v[52:55], v225, s[44:47], s30 offen sc1
    s_lshl_b32 s61, s56, 2
    s_lshr_b32 s31, s57, 2
    s_add_u32 s61, s61, s31
    s_add_u32 s61, s61, 64
    s_lshl_b32 s30, s61, 7
    s_add_u32 s30, s30, 0x910000
    v_mov_b32 v30, s75
    v_lshlrev_b32 v31, 7, v0
    s_waitcnt vmcnt(63)
    s_mov_b64 exec, 1
    s_setprio 3
    buffer_atomic_add v30, v31, s[44:47], s30 offen sc1
    s_setprio 0
    s_mov_b64 exec, -1
    s_lshl_b32 s30, s64, 10
    s_cmp_ge_u32 s64, s72
    s_cselect_b32 s30, 0x10000000, s30
    s_add_u32 s64, s64, 1
    buffer_load_dwordx4 v[56:59], v224, s[44:47], s30 offen sc1
    s_cmp_eq_u32 s64, 22
    s_cselect_b32 s64, 0, s64
    buffer_load_dwordx4 v[60:63], v225, s[44:47], s30 offen sc1
    s_lshl_b32 s30, s64, 10
    s_cmp_ge_u32 s64, s72
    s_cselect_b32 s30, 0x10000000, s30
    s_add_u32 s64, s64, 1
    buffer_load_dwordx4 v[64:67], v224, s[44:47], s30 offen sc1
    s_cmp_eq_u32 s64, 22
    s_cselect_b32 s64, 0, s64
    buffer_load_dwordx4 v[68:71], v225, s[44:47], s30 offen sc1
    s_lshl_b32 s30, s64, 10
    s_cmp_ge_u32 s64, s72
    s_cselect_b32 s30, 0x10000000, s30
    s_add_u32 s64, s64, 1
    buffer_load_dwordx4 v[72:75], v224, s[44:47], s30 offen sc1
    s_cmp_eq_u32 s64, 22
    s_cselect_b32 s64, 0, s64
    buffer_load_dwordx4 v[76:79], v225, s[44:47], s30 offen sc1
    s_lshl_b32 s30, s64, 10
    s_cmp_ge_u32 s64, s72
    s_cselect_b32 s30, 0x10000000, s30
    s_add_u32 s64, s64, 1
    buffer_load_dwordx4 v[80:83], v224, s[44:47], s30 offen sc1
    s_cmp_eq_u32 s64, 22
    s_cselect_b32 s64, 0, s64
    buffer_load_dwordx4 v[84:87], v225, s[44:47], s30 offen sc1
    s_waitcnt vmcnt(13) lgkmcnt(0)
    v_mfma_f32_32x32x16_bf16 v[120:135], v[96:99], v[32:35], 0
    v_mfma_f32_32x32x16_bf16 v[136:151], v[100:103], v[32:35], 0
    s_lshl_b32 s30, s64, 10
    s_cmp_ge_u32 s64, s72
    s_cselect_b32 s30, 0x10000000, s30
    s_add_u32 s64, s64, 1
    buffer_load_dwordx4 v[88:91], v224, s[44:47], s30 offen sc1
    v_mfma_f32_32x32x16_bf16 v[152:167], v[96:99], v[36:39], 0
    s_cmp_eq_u32 s64, 22
    s_cselect_b32 s64, 0, s64
    buffer_load_dwordx4 v[92:95], v225, s[44:47], s30 offen sc1
    v_mfma_f32_32x32x16_bf16 v[168:183], v[100:103], v[36:39], 0
    s_waitcnt vmcnt(13) lgkmcnt(0)
    v_mfma_f32_32x32x16_bf16 v[120:135], v[104:107], v[40:43], v[120:135]
    ds_read_b64_tr_b16 v[112:113], v226 offset:4096
    ds_read_b64_tr_b16 v[114:115], v226 offset:4608
    ds_read_b64_tr_b16 v[116:117], v227 offset:4096
    ds_read_b64_tr_b16 v[118:119], v227 offset:4608
    v_mfma_f32_32x32x16_bf16 v[136:151], v[108:111], v[40:43], v[136:151]
    s_lshl_b32 s30, s64, 10
    s_cmp_ge_u32 s64, s72
    s_cselect_b32 s30, 0x10000000, s30
    s_add_u32 s64, s64, 1
    buffer_load_dwordx4 v[32:35], v224, s[44:47], s30 offen sc1
    v_mfma_f32_32x32x16_bf16 v[152:167], v[104:107], v[44:47], v[152:167]
    s_cmp_eq_u32 s64, 22
    s_cselect_b32 s64, 0, s64
    buffer_load_dwordx4 v[36:39], v225, s[44:47], s30 offen sc1
    v_mfma_f32_32x32x16_bf16 v[168:183], v[108:111], v[44:47], v[168:183]
    s_waitcnt vmcnt(13) lgkmcnt(0)
    v_mfma_f32_32x32x16_bf16 v[120:135], v[112:115], v[48:51], v[120:135]
    ds_read_b64_tr_b16 v[96:97], v226 offset:6144
    ds_read_b64_tr_b16 v[98:99], v226 offset:6656
    ds_read_b64_tr_b16 v[100:101], v227 offset:6144
    ds_read_b64_tr_b16 v[102:103], v227 offset:6656
    v_mfma_f32_32x32x16_bf16 v[136:151], v[116:119], v[48:51], v[136:151]
    s_lshl_b32 s30, s64, 10
    s_cmp_ge_u32 s64, s72
    s_cselect_b32 s30, 0x10000000, s30
    s_add_u32 s64, s64, 1
    buffer_load_dwordx4 v[40:43], v224, s[44:47], s30 offen sc1
    v_mfma_f32_32x32x16_bf16 v[152:167], v[112:115], v[52:55], v[152:167]
    s_cmp_eq_u32 s64, 22
    s_cselect_b32 s64, 0, s64
    buffer_load_dwordx4 v[44:47], v225, s[44:47], s30 offen sc1
    v_mfma_f32_32x32x16_bf16 v[168:183], v[116:119], v[52:55], v[168:183]
    s_waitcnt vmcnt(12) lgkmcnt(0)
    v_mfma_f32_32x32x16_bf16 v[120:135], v[96:99], v[56:59], v[120:135]
    ds_read_b64_tr_b16 v[104:105], v226 offset:8192
    ds_read_b64_tr_b16 v[106:107], v226 offset:8704
    ds_read_b64_tr_b16 v[108:109], v227 offset:8192
    ds_read_b64_tr_b16 v[110:111], v227 offset:8704
    v_mfma_f32_32x32x16_bf16 v[136:151], v[100:103], v[56:59], v[136:151]
    s_lshl_b32 s30, s64, 10
    s_cmp_ge_u32 s64, s72
    s_cselect_b32 s30, 0x10000000, s30
    s_add_u32 s64, s64, 1
    buffer_load_dwordx4 v[48:51], v224, s[44:47], s30 offen sc1
    v_mfma_f32_32x32x16_bf16 v[152:167], v[96:99], v[60:63], v[152:167]
    s_cmp_eq_u32 s64, 22
    s_cselect_b32 s64, 0, s64
    buffer_load_dwordx4 v[52:55], v225, s[44:47], s30 offen sc1
    v_mfma_f32_32x32x16_bf16 v[168:183], v[100:103], v[60:63], v[168:183]
    s_waitcnt vmcnt(12) lgkmcnt(0)
    v_mfma_f32_32x32x16_bf16 v[120:135], v[104:107], v[64:67], v[120:135]
    ds_read_b64_tr_b16 v[112:113], v226 offset:40960
    ds_read_b64_tr_b16 v[114:115], v226 offset:41472
    ds_read_b64_tr_b16 v[116:117], v227 offset:40960
    ds_read_b64_tr_b16 v[118:119], v227 offset:41472
    v_mfma_f32_32x32x16_bf16 v[136:151], v[108:111], v[64:67], v[136:151]
    s_lshl_b32 s30, s64, 10
    s_cmp_ge_u32 s64, s72
    s_cselect_b32 s30, 0x10000000, s30
    s_add_u32 s64, s64, 1
    buffer_load_dwordx4 v[56:59], v224, s[44:47], s30 offen sc1
    v_mfma_f32_32x32x16_bf16 v[152:167], v[104:107], v[68:71], v[152:167]
    s_cmp_eq_u32 s64, 22
    s_cselect_b32 s64, 0, s64
    buffer_load_dwordx4 v[60:63], v225, s[44:47], s30 offen sc1
    v_mfma_f32_32x32x16_bf16 v[168:183], v[108:111], v[68:71], v[168:183]
    s_waitcnt vmcnt(12) lgkmcnt(0)
    v_mfma_f32_32x32x16_bf16 v[120:135], v[112:115], v[72:75], v[120:135]
    ds_read_b64_tr_b16 v[96:97], v226 offset:43008
    ds_read_b64_tr_b16 v[98:99], v226 offset:43520
    ds_read_b64_tr_b16 v[100:101], v227 offset:43008
    ds_read_b64_tr_b16 v[102:103], v227 offset:43520
    v_mfma_f32_32x32x16_bf16 v[136:151], v[116:119], v[72:75], v[136:151]
    s_lshl_b32 s30, s64, 10
    s_cmp_ge_u32 s64, s72
    s_cselect_b32 s30, 0x10000000, s30
    s_add_u32 s64, s64, 1
    buffer_load_dwordx4 v[64:67], v224, s[44:47], s30 offen sc1
    v_mfma_f32_32x32x16_bf16 v[152:167], v[112:115], v[76:79], v[152:167]
    s_cmp_eq_u32 s64, 22
    s_cselect_b32 s64, 0, s64
    buffer_load_dwordx4 v[68:71], v225, s[44:47], s30 offen sc1
    v_mfma_f32_32x32x16_bf16 v[168:183], v[116:119], v[76:79], v[168:183]
    s_waitcnt vmcnt(12) lgkmcnt(0)
    v_mfma_f32_32x32x16_bf16 v[120:135], v[96:99], v[80:83], v[120:135]
    ds_read_b64_tr_b16 v[104:105], v226 offset:45056
    ds_read_b64_tr_b16 v[106:107], v226 offset:45568
    ds_read_b64_tr_b16 v[108:109], v227 offset:45056
    ds_read_b64_tr_b16 v[110:111], v227 offset:45568
    v_mfma_f32_32x32x16_bf16 v[136:151], v[100:103], v[80:83], v[136:151]
    s_lshl_b32 s30, s64, 10
    s_cmp_ge_u32 s64, s72
    s_cselect_b32 s30, 0x10000000, s30
    s_add_u32 s64, s64, 1
    buffer_load_dwordx4 v[72:75], v224, s[44:47], s30 offen sc1
    v_mfma_f32_32x32x16_bf16 v[152:167], v[96:99], v[84:87], v[152:167]
    s_cmp_eq_u32 s64, 22
    s_cselect_b32 s64, 0, s64
    buffer_load_dwordx4 v[76:79], v225, s[44:47], s30 offen sc1
    v_mfma_f32_32x32x16_bf16 v[168:183], v[100:103], v[84:87], v[168:183]
    s_waitcnt vmcnt(12) lgkmcnt(0)
    v_mfma_f32_32x32x16_bf16 v[120:135], v[104:107], v[88:91], v[120:135]
    ds_read_b64_tr_b16 v[112:113], v226 offset:47104
    ds_read_b64_tr_b16 v[114:115], v226 offset:47616
    ds_read_b64_tr_b16 v[116:117], v227 offset:47104
    ds_read_b64_tr_b16 v[118:119], v227 offset:47616
    v_mfma_f32_32x32x16_bf16 v[136:151], v[108:111], v[88:91], v[136:151]
    s_lshl_b32 s30, s64, 10
    s_cmp_ge_u32 s64, s72
    s_cselect_b32 s30, 0x10000000, s30
    s_add_u32 s64, s64, 1
    buffer_load_dwordx4 v[80:83], v224, s[44:47], s30 offen sc1
    v_mfma_f32_32x32x16_bf16 v[152:167], v[104:107], v[92:95], v[152:167]
    s_cmp_eq_u32 s64, 22
    s_cselect_b32 s64, 0, s64
    buffer_load_dwordx4 v[84:87], v225, s[44:47], s30 offen sc1
    v_mfma_f32_32x32x16_bf16 v[168:183], v[108:111], v[92:95], v[168:183]
    s_waitcnt vmcnt(12) lgkmcnt(0)
    v_mfma_f32_32x32x16_bf16 v[120:135], v[112:115], v[32:35], v[120:135]
    ds_read_b64_tr_b16 v[96:97], v226 offset:49152
    ds_read_b64_tr_b16 v[98:99], v226 offset:49664
    ds_read_b64_tr_b16 v[100:101], v227 offset:49152
    ds_read_b64_tr_b16 v[102:103], v227 offset:49664
    v_mfma_f32_32x32x16_bf16 v[136:151], v[116:119], v[32:35], v[136:151]
    s_lshl_b32 s30, s64, 10
    s_cmp_ge_u32 s64, s72
    s_cselect_b32 s30, 0x10000000, s30
    s_add_u32 s64, s64, 1
    buffer_load_dwordx4 v[88:91], v224, s[44:47], s30 offen sc1
    v_mfma_f32_32x32x16_bf16 v[152:167], v[112:115], v[36:39], v[152:167]
    s_cmp_eq_u32 s64, 22
    s_cselect_b32 s64, 0, s64
    buffer_load_dwordx4 v[92:95], v225, s[44:47], s30 offen sc1
    v_mfma_f32_32x32x16_bf16 v[168:183], v[116:119], v[36:39], v[168:183]
    s_waitcnt vmcnt(12) lgkmcnt(0)
    v_mfma_f32_32x32x16_bf16 v[120:135], v[96:99], v[40:43], v[120:135]
    ds_read_b64_tr_b16 v[104:105], v228 offset:0
    ds_read_b64_tr_b16 v[106:107], v228 offset:512
    ds_read_b64_tr_b16 v[108:109], v229 offset:0
    ds_read_b64_tr_b16 v[110:111], v229 offset:512
    v_mfma_f32_32x32x16_bf16 v[136:151], v[100:103], v[40:43], v[136:151]
    s_lshl_b32 s30, s64, 10
    s_cmp_ge_u32 s64, s72
    s_cselect_b32 s30, 0x10000000, s30
    s_add_u32 s64, s64, 1
    buffer_load_dwordx4 v[32:35], v224, s[44:47], s30 offen sc1
    v_mfma_f32_32x32x16_bf16 v[152:167], v[96:99], v[44:47], v[152:167]
    s_cmp_eq_u32 s64, 22
    s_cselect_b32 s64, 0, s64
    buffer_load_dwordx4 v[36:39], v225, s[44:47], s30 offen sc1
    v_mfma_f32_32x32x16_bf16 v[168:183], v[100:103], v[44:47], v[168:183]
    s_waitcnt vmcnt(12) lgkmcnt(0)
    v_mfma_f32_32x32x16_bf16 v[120:135], v[104:107], v[48:51], v[120:135]
    ds_read_b64_tr_b16 v[112:113], v228 offset:2048
    ds_read_b64_tr_b16 v[114:115], v228 offset:2560
    ds_read_b64_tr_b16 v[116:117], v229 offset:2048
    ds_read_b64_tr_b16 v[118:119], v229 offset:2560
    v_mfma_f32_32x32x16_bf16 v[136:151], v[108:111], v[48:51], v[136:151]
    s_lshl_b32 s30, s64, 10
    s_cmp_ge_u32 s64, s72
    s_cselect_b32 s30, 0x10000000, s30
    s_add_u32 s64, s64, 1
    buffer_load_dwordx4 v[40:43], v224, s[44:47], s30 offen sc1
    v_mfma_f32_32x32x16_bf16 v[152:167], v[104:107], v[52:55], v[152:167]
    s_cmp_eq_u32 s64, 22
    s_cselect_b32 s64, 0, s64
    buffer_load_dwordx4 v[44:47], v225, s[44:47], s30 offen sc1
    v_mfma_f32_32x32x16_bf16 v[168:183], v[108:111], v[52:55], v[168:183]
    s_waitcnt vmcnt(12) lgkmcnt(0)
    v_mfma_f32_32x32x16_bf16 v[120:135], v[112:115], v[56:59], v[120:135]
    ds_read_b64_tr_b16 v[96:97], v228 offset:4096
    ds_read_b64_tr_b16 v[98:99], v228 offset:4608
    ds_read_b64_tr_b16 v[100:101], v229 offset:4096
    ds_read_b64_tr_b16 v[102:103], v229 offset:4608
    v_mfma_f32_32x32x16_bf16 v[136:151], v[116:119], v[56:59], v[136:151]
    s_lshl_b32 s30, s64, 10
    s_cmp_ge_u32 s64, s72
    s_cselect_b32 s30, 0x10000000, s30
    s_add_u32 s64, s64, 1
    buffer_load_dwordx4 v[48:51], v224, s[44:47], s30 offen sc1
    v_mfma_f32_32x32x16_bf16 v[152:167], v[112:115], v[60:63], v[152:167]
    s_cmp_eq_u32 s64, 22
    s_cselect_b32 s64, 0, s64
    buffer_load_dwordx4 v[52:55], v225, s[44:47], s30 offen sc1
    v_mfma_f32_32x32x16_bf16 v[168:183], v[116:119], v[60:63], v[168:183]
    s_barrier
    s_waitcnt vmcnt(12) lgkmcnt(0)
    v_mfma_f32_32x32x16_bf16 v[120:135], v[96:99], v[64:67], v[120:135]
    ds_read_b64_tr_b16 v[104:105], v228 offset:6144
    ds_read_b64_tr_b16 v[106:107], v228 offset:6656
    ds_read_b64_tr_b16 v[108:109], v229 offset:6144
    ds_read_b64_tr_b16 v[110:111], v229 offset:6656
    v_mfma_f32_32x32x16_bf16 v[136:151], v[100:103], v[64:67], v[136:151]
    s_lshl_b32 s30, s64, 10
    s_cmp_ge_u32 s64, s72
    s_cselect_b32 s30, 0x10000000, s30
    s_add_u32 s64, s64, 1
    buffer_load_dwordx4 v[56:59], v224, s[44:47], s30 offen sc1
    v_mfma_f32_32x32x16_bf16 v[152:167], v[96:99], v[68:71], v[152:167]
    s_cmp_eq_u32 s64, 22
    s_cselect_b32 s64, 0, s64
    buffer_load_dwordx4 v[60:63], v225, s[44:47], s30 offen sc1
    v_mfma_f32_32x32x16_bf16 v[168:183], v[100:103], v[68:71], v[168:183]
    s_waitcnt vmcnt(12) lgkmcnt(0)
    v_mfma_f32_32x32x16_bf16 v[120:135], v[104:107], v[72:75], v[120:135]
    ds_read_b64_tr_b16 v[112:113], v228 offset:8192
    ds_read_b64_tr_b16 v[114:115], v228 offset:8704
    ds_read_b64_tr_b16 v[116:117], v229 offset:8192
    ds_read_b64_tr_b16 v[118:119], v229 offset:8704
    v_mfma_f32_32x32x16_bf16 v[136:151], v[108:111], v[72:75], v[136:151]
    s_lshl_b32 s30, s64, 10
    s_cmp_ge_u32 s64, s72
    s_cselect_b32 s30, 0x10000000, s30
    s_add_u32 s64, s64, 1
    buffer_load_dwordx4 v[64:67], v224, s[44:47], s30 offen sc1
    v_mfma_f32_32x32x16_bf16 v[152:167], v[104:107], v[76:79], v[152:167]
    s_cmp_eq_u32 s64, 22
    s_cselect_b32 s64, 0, s64
    buffer_load_dwordx4 v[68:71], v225, s[44:47], s30 offen sc1
    v_mfma_f32_32x32x16_bf16 v[168:183], v[108:111], v[76:79], v[168:183]
    s_waitcnt vmcnt(12) lgkmcnt(0)
    v_mfma_f32_32x32x16_bf16 v[120:135], v[112:115], v[80:83], v[120:135]
    ds_read_b64_tr_b16 v[96:97], v228 offset:40960
    ds_read_b64_tr_b16 v[98:99], v228 offset:41472
    ds_read_b64_tr_b16 v[100:101], v229 offset:40960
    ds_read_b64_tr_b16 v[102:103], v229 offset:41472
    v_mfma_f32_32x32x16_bf16 v[136:151], v[116:119], v[80:83], v[136:151]
    s_lshl_b32 s30, s64, 10
    s_cmp_ge_u32 s64, s72
    s_cselect_b32 s30, 0x10000000, s30
    s_add_u32 s64, s64, 1
    buffer_load_dwordx4 v[72:75], v224, s[44:47], s30 offen sc1
    v_mfma_f32_32x32x16_bf16 v[152:167], v[112:115], v[84:87], v[152:167]
    s_cmp_eq_u32 s64, 22
    s_cselect_b32 s64, 0, s64
    buffer_load_dwordx4 v[76:79], v225, s[44:47], s30 offen sc1
    v_mfma_f32_32x32x16_bf16 v[168:183], v[116:119], v[84:87], v[168:183]
    s_waitcnt vmcnt(12) lgkmcnt(0)
    v_mfma_f32_32x32x16_bf16 v[120:135], v[96:99], v[88:91], v[120:135]
    ds_read_b64_tr_b16 v[104:105], v228 offset:43008
    ds_read_b64_tr_b16 v[106:107], v228 offset:43520
    ds_read_b64_tr_b16 v[108:109], v229 offset:43008
    ds_read_b64_tr_b16 v[110:111], v229 offset:43520
    v_mfma_f32_32x32x16_bf16 v[136:151], v[100:103], v[88:91], v[136:151]
    v_mfma_f32_32x32x16_bf16 v[152:167], v[96:99], v[92:95], v[152:167]
    v_mfma_f32_32x32x16_bf16 v[168:183], v[100:103], v[92:95], v[168:183]
    s_waitcnt vmcnt(10) lgkmcnt(0)
    v_mfma_f32_32x32x16_bf16 v[120:135], v[104:107], v[32:35], v[120:135]
    ds_read_b64_tr_b16 v[112:113], v228 offset:45056
    ds_read_b64_tr_b16 v[114:115], v228 offset:45568
    ds_read_b64_tr_b16 v[116:117], v229 offset:45056
    ds_read_b64_tr_b16 v[118:119], v229 offset:45568
    v_mfma_f32_32x32x16_bf16 v[136:151], v[108:111], v[32:35], v[136:151]
    v_mfma_f32_32x32x16_bf16 v[152:167], v[104:107], v[36:39], v[152:167]
    v_mfma_f32_32x32x16_bf16 v[168:183], v[108:111], v[36:39], v[168:183]
    s_waitcnt vmcnt(8) lgkmcnt(0)
    v_mfma_f32_32x32x16_bf16 v[120:135], v[112:115], v[40:43], v[120:135]
    ds_read_b64_tr_b16 v[96:97], v228 offset:47104
    ds_read_b64_tr_b16 v[98:99], v228 offset:47616
    ds_read_b64_tr_b16 v[100:101], v229 offset:47104
    ds_read_b64_tr_b16 v[102:103], v229 offset:47616
    v_mfma_f32_32x32x16_bf16 v[136:151], v[116:119], v[40:43], v[136:151]
    v_mfma_f32_32x32x16_bf16 v[152:167], v[112:115], v[44:47], v[152:167]
    v_mfma_f32_32x32x16_bf16 v[168:183], v[116:119], v[44:47], v[168:183]
    s_waitcnt vmcnt(6) lgkmcnt(0)
    v_mfma_f32_32x32x16_bf16 v[120:135], v[96:99], v[48:51], v[120:135]
    ds_read_b64_tr_b16 v[104:105], v228 offset:49152
    ds_read_b64_tr_b16 v[106:107], v228 offset:49664
    ds_read_b64_tr_b16 v[108:109], v229 offset:49152
    ds_read_b64_tr_b16 v[110:111], v229 offset:49664
    v_mfma_f32_32x32x16_bf16 v[136:151], v[100:103], v[48:51], v[136:151]
    v_mfma_f32_32x32x16_bf16 v[152:167], v[96:99], v[52:55], v[152:167]
    v_mfma_f32_32x32x16_bf16 v[168:183], v[100:103], v[52:55], v[168:183]
    s_waitcnt vmcnt(4) lgkmcnt(0)
    v_mfma_f32_32x32x16_bf16 v[120:135], v[104:107], v[56:59], v[120:135]
    ds_read_b64_tr_b16 v[112:113], v226 offset:0
    ds_read_b64_tr_b16 v[114:115], v226 offset:512
    ds_read_b64_tr_b16 v[116:117], v227 offset:0
    ds_read_b64_tr_b16 v[118:119], v227 offset:512
    v_mfma_f32_32x32x16_bf16 v[136:151], v[108:111], v[56:59], v[136:151]
    v_mfma_f32_32x32x16_bf16 v[152:167], v[104:107], v[60:63], v[152:167]
    v_mfma_f32_32x32x16_bf16 v[168:183], v[108:111], v[60:63], v[168:183]
    s_waitcnt vmcnt(2) lgkmcnt(0)
    v_mfma_f32_32x32x16_bf16 v[120:135], v[112:115], v[64:67], v[120:135]
    ds_read_b64_tr_b16 v[96:97], v226 offset:2048
    ds_read_b64_tr_b16 v[98:99], v226 offset:2560
    ds_read_b64_tr_b16 v[100:101], v227 offset:2048
    ds_read_b64_tr_b16 v[102:103], v227 offset:2560
    v_mfma_f32_32x32x16_bf16 v[136:151], v[116:119], v[64:67], v[136:151]
    v_mfma_f32_32x32x16_bf16 v[152:167], v[112:115], v[68:71], v[152:167]
    v_mfma_f32_32x32x16_bf16 v[168:183], v[116:119], v[68:71], v[168:183]
    s_waitcnt vmcnt(0) lgkmcnt(0)
    v_mfma_f32_32x32x16_bf16 v[120:135], v[96:99], v[72:75], v[120:135]
    v_mfma_f32_32x32x16_bf16 v[136:151], v[100:103], v[72:75], v[136:151]
    v_mfma_f32_32x32x16_bf16 v[152:167], v[96:99], v[76:79], v[152:167]
    v_mfma_f32_32x32x16_bf16 v[168:183], v[100:103], v[76:79], v[168:183]
    s_nop 8
    ds_write_b128 v240, v[120:123] offset:0
    ds_write_b128 v241, v[124:127] offset:1024
    ds_write_b128 v242, v[128:131] offset:2048
    ds_write_b128 v243, v[132:135] offset:3072
    ds_write_b128 v240, v[136:139] offset:40960
    ds_write_b128 v241, v[140:143] offset:41984
    ds_write_b128 v242, v[144:147] offset:43008
    ds_write_b128 v243, v[148:151] offset:44032
    ds_write_b128 v244, v[152:155] offset:0
    ds_write_b128 v245, v[156:159] offset:1024
    ds_write_b128 v246, v[160:163] offset:2048
    ds_write_b128 v247, v[164:167] offset:3072
    ds_write_b128 v244, v[168:171] offset:40960
    ds_write_b128 v245, v[172:175] offset:41984
    ds_write_b128 v246, v[176:179] offset:43008
    ds_write_b128 v247, v[180:183] offset:44032
    s_waitcnt lgkmcnt(0)
    s_barrier
    s_mov_b32 s48, s24
    s_mov_b32 s49, s25
    s_mov_b32 s50, 0x200000
    s_mov_b32 s51, 0x20000
    ds_read_b32 v252, v250 offset:8192
    ds_read_b128 v[32:35], v249 offset:0
    ds_read_b128 v[40:43], v249 offset:10240
    ds_read_b128 v[48:51], v249 offset:20480
    ds_read_b128 v[56:59], v249 offset:30720
    ds_read_b128 v[64:67], v251 offset:4096
    ds_read_b128 v[36:39], v249 offset:512
    ds_read_b128 v[44:47], v249 offset:10752
    ds_read_b128 v[52:55], v249 offset:20992
    ds_read_b128 v[60:63], v249 offset:31232
    ds_read_b128 v[68:71], v251 offset:4608
    s_waitcnt lgkmcnt(5)
    v_pk_add_f32 v[32:33], v[32:33], v[40:41]
    v_pk_add_f32 v[48:49], v[48:49], v[56:57]
    v_pk_add_f32 v[34:35], v[34:35], v[42:43]
    v_pk_add_f32 v[50:51], v[50:51], v[58:59]
    v_pk_add_f32 v[32:33], v[32:33], v[48:49]
    v_pk_add_f32 v[34:35], v[34:35], v[50:51]
    v_fma_f32 v32, v252, v32, v64
    v_fma_f32 v33, v252, v33, v65
    v_fma_f32 v34, v252, v34, v66
    v_fma_f32 v35, v252, v35, v67
    v_cvt_pk_bf16_f32 v72, v32, v33
    v_cvt_pk_bf16_f32 v73, v34, v35
    s_waitcnt lgkmcnt(0)
    v_pk_add_f32 v[36:37], v[36:37], v[44:45]
    v_pk_add_f32 v[52:53], v[52:53], v[60:61]
    v_pk_add_f32 v[38:39], v[38:39], v[46:47]
    v_pk_add_f32 v[54:55], v[54:55], v[62:63]
    v_pk_add_f32 v[36:37], v[36:37], v[52:53]
    v_pk_add_f32 v[38:39], v[38:39], v[54:55]
    v_fma_f32 v36, v252, v36, v68
    v_fma_f32 v37, v252, v37, v69
    v_fma_f32 v38, v252, v38, v70
    v_fma_f32 v39, v252, v39, v71
    v_cvt_pk_bf16_f32 v74, v36, v37
    v_cvt_pk_bf16_f32 v75, v38, v39
    buffer_store_dwordx4 v[72:75], v248, s[48:51], 0 offen sc1
    s_endpgm
P1_CONS:
    s_setprio 3
    s_lshr_b32 s30, s2, 3
    s_lshl_b32 s30, s30, 1
    s_and_b32 s31, s2, 1
    s_add_u32 s30, s30, s31
    s_lshl_b32 s30, s30, 2
    s_add_u32 s30, s30, s3
    s_lshl_b32 s30, s30, 13
    v_lshlrev_b32 v1, 10, v0
    s_mov_b32 s34, 0x200000
    s_mov_b32 s35, 0x20000
    s_mov_b64 exec, 0xff
    s_waitcnt lgkmcnt(0)
    buffer_load_dword v13, v1, s[32:35], s30 offen offset:384
    s_mov_b64 exec, -1
    s_setprio 0
    s_lshr_b32 s66, s3, 1
    s_and_b32 s67, s3, 1
    v_and_b32 v1, 15, v0
    v_lshrrev_b32 v2, 4, v0
    v_lshrrev_b32 v3, 1, v1
    v_xor_b32 v3, v3, v2
    v_lshlrev_b32 v3, 4, v3
    v_lshl_add_u32 v4, v1, 7, v3
    v_lshrrev_b32 v3, 2, v1
    v_lshl_add_u32 v3, v2, 3, v3
    v_and_b32 v11, 3, v0
    s_mov_b32 s72, 0xbdd2d3e8
    v_mov_b32 v10, 0xc0135761
    s_mov_b32 s68, 0
    s_mov_b32 s82, 4294844416
    s_mov_b32 s83, 40960
    s_cmp_eq_u32 s58, 1
    s_cbranch_scc1 P1_CSP
    s_mov_b32 s73, 99
    s_lshr_b32 s30, s2, 3
    s_xor_b32 s30, s30, 8
    s_xor_b32 s31, s3, 1
    s_or_b32 s30, s30, s31
    s_cbranch_scc1 NOINIT
    s_setprio 3
    v_mov_b32 v16, 0
    v_lshlrev_b32 v17, 7, v0
    s_and_b32 s31, s2, 7
    s_mul_i32 s30, s31, 6144
    s_add_u32 s30, s30, 0x910000
    s_mov_b32 exec_hi, 0xffff
    s_waitcnt lgkmcnt(0)
    s_mov_b32 s44, s28
    s_mov_b32 s45, s29
    s_mov_b32 s46, 0x920000
    s_mov_b32 s47, 0x20000
    buffer_store_dword v16, v17, s[44:47], s30 offen sc0 sc1
    s_mov_b64 exec, -1
    s_mov_b32 s73, 2
    s_setprio 0
NOINIT:
    s_lshl_b32 s30, s66, 13
    v_add_u32 v4, s30, v4
    v_xor_b32 v5, 64, v4
    v_mul_u32_u24 v3, 192, v3
    v_lshl_add_u32 v3, v11, 3, v3
    s_mul_i32 s30, s67, 96
    s_add_u32 s30, s30, 16384
    v_add_u32 v3, s30, v3
    v_and_b32 v8, 1, v2
    v_lshlrev_b32 v8, 5, v8
    v_add_u32 v6, v3, v8
    v_sub_u32 v7, v3, v8
    s_cmp_eq_u32 s67, 0
    s_cbranch_scc1 P1_NOSWAP
    v_swap_b32 v6, v7
P1_NOSWAP:
    v_mov_b32 v96, 0
    v_mov_b32 v97, 0
    v_mov_b32 v98, 0
    v_mov_b32 v99, 0
    v_mov_b32 v100, 0
    v_mov_b32 v101, 0
    v_mov_b32 v102, 0
    v_mov_b32 v103, 0
    v_mov_b32 v104, 0
    v_mov_b32 v105, 0
    v_mov_b32 v106, 0
    v_mov_b32 v107, 0
    v_mov_b32 v108, 0
    v_mov_b32 v109, 0
    v_mov_b32 v110, 0
    v_mov_b32 v111, 0
    v_mov_b32 v112, 0
    v_mov_b32 v113, 0
    v_mov_b32 v114, 0
    v_mov_b32 v115, 0
    v_mov_b32 v116, 0
    v_mov_b32 v117, 0
    v_mov_b32 v118, 0
    v_mov_b32 v119, 0
    v_mov_b32 v120, 0
    v_mov_b32 v121, 0
    v_mov_b32 v122, 0
    v_mov_b32 v123, 0
    v_mov_b32 v124, 0
    v_mov_b32 v125, 0
    v_mov_b32 v126, 0
    v_mov_b32 v127, 0
    v_mov_b32 v128, 0
    v_mov_b32 v129, 0
    v_mov_b32 v130, 0
    v_mov_b32 v131, 0
    v_mov_b32 v132, 0
    v_mov_b32 v133, 0
    v_mov_b32 v134, 0
    v_mov_b32 v135, 0
    v_mov_b32 v136, 0
    v_mov_b32 v137, 0
    v_mov_b32 v138, 0
    v_mov_b32 v139, 0
    v_mov_b32 v140, 0
    v_mov_b32 v141, 0
    v_mov_b32 v142, 0
    v_mov_b32 v143, 0
    v_mov_b32 v144, 0
    v_mov_b32 v145, 0
    v_mov_b32 v146, 0
    v_mov_b32 v147, 0
    v_mov_b32 v148, 0
    v_mov_b32 v149, 0
    v_mov_b32 v150, 0
    v_mov_b32 v151, 0
    v_mov_b32 v152, 0
    v_mov_b32 v153, 0
    v_mov_b32 v154, 0
    v_mov_b32 v155, 0
    v_mov_b32 v156, 0
    v_mov_b32 v157, 0
    v_mov_b32 v158, 0
    v_mov_b32 v159, 0
    v_mov_b32 v160, 0
    v_mov_b32 v161, 0
    v_mov_b32 v162, 0
    v_mov_b32 v163, 0
    v_mov_b32 v164, 0
    v_mov_b32 v165, 0
    v_mov_b32 v166, 0
    v_mov_b32 v167, 0
    v_mov_b32 v168, 0
    v_mov_b32 v169, 0
    v_mov_b32 v170, 0
    v_mov_b32 v171, 0
    v_mov_b32 v172, 0
    v_mov_b32 v173, 0
    v_mov_b32 v174, 0
    v_mov_b32 v175, 0
    v_mov_b32 v176, 0
    v_mov_b32 v177, 0
    v_mov_b32 v178, 0
    v_mov_b32 v179, 0
    v_mov_b32 v180, 0
    v_mov_b32 v181, 0
    v_mov_b32 v182, 0
    v_mov_b32 v183, 0
    v_mov_b32 v184, 0
    v_mov_b32 v185, 0
    v_mov_b32 v186, 0
    v_mov_b32 v187, 0
    v_mov_b32 v188, 0
    v_mov_b32 v189, 0
    v_mov_b32 v190, 0
    v_mov_b32 v191, 0
    v_lshlrev_b32 v3, 4, v0
    s_mul_i32 s69, s78, 6
    s_mul_i32 s30, s67, 3
    s_add_u32 s69, s69, s30
    s_lshl_b32 s30, s56, 2
    s_lshl_b32 s31, s66, 1
    s_add_u32 s30, s30, s31
    s_mul_i32 s30, s30, 86
    s_add_u32 s30, s30, s69
    s_lshl_b32 s70, s30, 10
    s_add_u32 s71, s70, 88064
    s_and_b32 s30, s2, 7
    s_lshr_b32 s31, s2, 3
    s_lshr_b32 s93, s31, 2
    s_xor_b32 s93, s93, 5
    s_and_b32 s31, s31, 3
    s_mul_i32 s94, s31, 6
    s_sub_u32 s61, 0, s30
    s_bitcmp1_b32 s31, 0
    s_cselect_b32 s92, s61, s30
    s_cselect_b32 s61, 8, 0
    s_cmp_eq_u32 s30, 0
    s_cselect_b32 s92, s61, s92
    s_lshr_b32 s31, s31, 1
    s_lshl_b32 s31, s31, 4
    s_add_u32 s92, s92, s31
    s_and_b32 s92, s92, 31
    s_mul_i32 s30, s93, 0
    s_add_u32 s94, s94, s30
    s_sub_u32 s30, s94, 22
    s_cmp_ge_u32 s94, 22
    s_cselect_b32 s94, s30, s94
    v_lshrrev_b32 v228, 5, v0
    v_and_b32 v229, 31, v0
    s_lshl_b32 s31, s93, 6
    s_lshl_b32 s61, s67, 5
    s_add_u32 s31, s31, s61
    s_lshl_b32 s30, s66, 5
    s_add_u32 s30, s30, s92
    v_lshlrev_b32 v232, 6, v229
    v_add_u32 v232, s30, v232
    v_lshrrev_b32 v231, 1, v229
    v_lshlrev_b32 v231, 7, v231
    v_and_b32 v224, 1, v229
    v_lshl_add_u32 v231, v224, 2, v231
    s_lshl_b32 s61, s30, 11
    v_add_u32 v231, s61, v231
    s_lshr_b32 s64, s30, 2
    s_sub_u32 s61, 32, s92
    s_and_b32 s61, s61, 31
    s_sub_u32 s65, 481, s31
    s_cmp_ge_u32 s93, 4
    s_cselect_b32 s79, s61, s92
    s_cselect_b64 vcc, -1, 0
    s_cselect_b32 s76, 1.0, -1.0
    s_cselect_b32 s65, s65, s31
    v_add_u32 v224, s31, v229
    v_sub_u32 v225, 0x200, v224
    v_cndmask_b32 v224, v224, v225, vcc
    v_lshrrev_b32 v226, 4, v0
    v_lshlrev_b32 v226, 4, v226
    v_min_u32 v226, 31, v226
    v_add_u32 v226, s65, v226
    v_sub_u32 v225, 384, v224
    v_cmp_gt_u32 vcc, 128, v224
    s_nop 1
    v_cndmask_b32 v224, v225, v224, vcc
    v_sub_u32 v225, 384, v226
    v_cmp_gt_u32 vcc, 128, v226
    s_nop 1
    v_cndmask_b32 v226, v225, v226, vcc
    v_mul_u32_u24 v225, 2112, v228
    v_add_u32 v224, v224, v225
    v_lshlrev_b32 v224, 4, v224
    s_mul_i32 s79, s79, 67584
    s_add_u32 s79, s79, 0x600000
    v_bfe_u32 v226, v226, 4, 3
    s_lshr_b32 s61, s2, 1
    s_xor_b32 s61, s61, s2
    s_lshl_b32 s64, s66, 4
    s_add_u32 s61, s61, s64
    s_and_b32 s61, s61, 31
    s_add_u32 s61, s61, 128
    v_lshl_add_u32 v226, v226, 5, s61
    s_add_u32 s61, s30, 64
    v_mov_b32 v225, s61
    v_cmp_gt_u32 vcc, 48, v0
    s_nop 1
    v_cndmask_b32 v226, v225, v226, vcc
    v_lshlrev_b32 v226, 7, v226
    v_cvt_f32_u32 v229, v232
    v_mul_f32 v229, 0x3a000000, v229
    v_mul_f32 v229, s76, v229
    v_lshlrev_b32 v230, 5, v228
    v_cvt_f32_u32 v230, v230
    v_mul_f32 v230, v230, v229
    v_cos_f32 v16, v230
    v_sin_f32 v20, v230
    v_add_f32 v230, v230, v229
    v_cos_f32 v17, v230
    v_sin_f32 v21, v230
    v_add_f32 v230, v230, v229
    v_cos_f32 v18, v230
    v_sin_f32 v22, v230
    v_add_f32 v230, v230, v229
    v_cos_f32 v19, v230
    v_sin_f32 v23, v230
    v_add_f32 v230, v230, v229
    v_cvt_pk_bf16_f32 v192, v16, v17
    v_cvt_pk_bf16_f32 v193, v18, v19
    v_cvt_pk_bf16_f32 v194, v20, v21
    v_cvt_pk_bf16_f32 v195, v22, v23
    v_cos_f32 v16, v230
    v_sin_f32 v20, v230
    v_add_f32 v230, v230, v229
    v_cos_f32 v17, v230
    v_sin_f32 v21, v230
    v_add_f32 v230, v230, v229
    v_cos_f32 v18, v230
    v_sin_f32 v22, v230
    v_add_f32 v230, v230, v229
    v_cos_f32 v19, v230
    v_sin_f32 v23, v230
    v_add_f32 v230, v230, v229
    v_cvt_pk_bf16_f32 v196, v16, v17
    v_cvt_pk_bf16_f32 v197, v18, v19
    v_cvt_pk_bf16_f32 v198, v20, v21
    v_cvt_pk_bf16_f32 v199, v22, v23
    v_cos_f32 v16, v230
    v_sin_f32 v20, v230
    v_add_f32 v230, v230, v229
    v_cos_f32 v17, v230
    v_sin_f32 v21, v230
    v_add_f32 v230, v230, v229
    v_cos_f32 v18, v230
    v_sin_f32 v22, v230
    v_add_f32 v230, v230, v229
    v_cos_f32 v19, v230
    v_sin_f32 v23, v230
    v_add_f32 v230, v230, v229
    v_cvt_pk_bf16_f32 v200, v16, v17
    v_cvt_pk_bf16_f32 v201, v18, v19
    v_cvt_pk_bf16_f32 v202, v20, v21
    v_cvt_pk_bf16_f32 v203, v22, v23
    v_cos_f32 v16, v230
    v_sin_f32 v20, v230
    v_add_f32 v230, v230, v229
    v_cos_f32 v17, v230
    v_sin_f32 v21, v230
    v_add_f32 v230, v230, v229
    v_cos_f32 v18, v230
    v_sin_f32 v22, v230
    v_add_f32 v230, v230, v229
    v_cos_f32 v19, v230
    v_sin_f32 v23, v230
    v_add_f32 v230, v230, v229
    v_cvt_pk_bf16_f32 v204, v16, v17
    v_cvt_pk_bf16_f32 v205, v18, v19
    v_cvt_pk_bf16_f32 v206, v20, v21
    v_cvt_pk_bf16_f32 v207, v22, v23
    v_cos_f32 v16, v230
    v_sin_f32 v20, v230
    v_add_f32 v230, v230, v229
    v_cos_f32 v17, v230
    v_sin_f32 v21, v230
    v_add_f32 v230, v230, v229
    v_cos_f32 v18, v230
    v_sin_f32 v22, v230
    v_add_f32 v230, v230, v229
    v_cos_f32 v19, v230
    v_sin_f32 v23, v230
    v_add_f32 v230, v230, v229
    v_cvt_pk_bf16_f32 v208, v16, v17
    v_cvt_pk_bf16_f32 v209, v18, v19
    v_cvt_pk_bf16_f32 v210, v20, v21
    v_cvt_pk_bf16_f32 v211, v22, v23
    v_cos_f32 v16, v230
    v_sin_f32 v20, v230
    v_add_f32 v230, v230, v229
    v_cos_f32 v17, v230
    v_sin_f32 v21, v230
    v_add_f32 v230, v230, v229
    v_cos_f32 v18, v230
    v_sin_f32 v22, v230
    v_add_f32 v230, v230, v229
    v_cos_f32 v19, v230
    v_sin_f32 v23, v230
    v_add_f32 v230, v230, v229
    v_cvt_pk_bf16_f32 v212, v16, v17
    v_cvt_pk_bf16_f32 v213, v18, v19
    v_cvt_pk_bf16_f32 v214, v20, v21
    v_cvt_pk_bf16_f32 v215, v22, v23
    v_cos_f32 v16, v230
    v_sin_f32 v20, v230
    v_add_f32 v230, v230, v229
    v_cos_f32 v17, v230
    v_sin_f32 v21, v230
    v_add_f32 v230, v230, v229
    v_cos_f32 v18, v230
    v_sin_f32 v22, v230
    v_add_f32 v230, v230, v229
    v_cos_f32 v19, v230
    v_sin_f32 v23, v230
    v_add_f32 v230, v230, v229
    v_cvt_pk_bf16_f32 v216, v16, v17
    v_cvt_pk_bf16_f32 v217, v18, v19
    v_cvt_pk_bf16_f32 v218, v20, v21
    v_cvt_pk_bf16_f32 v219, v22, v23
    v_cos_f32 v16, v230
    v_sin_f32 v20, v230
    v_add_f32 v230, v230, v229
    v_cos_f32 v17, v230
    v_sin_f32 v21, v230
    v_add_f32 v230, v230, v229
    v_cos_f32 v18, v230
    v_sin_f32 v22, v230
    v_add_f32 v230, v230, v229
    v_cos_f32 v19, v230
    v_sin_f32 v23, v230
    v_add_f32 v230, v230, v229
    v_cvt_pk_bf16_f32 v220, v16, v17
    v_cvt_pk_bf16_f32 v221, v18, v19
    v_cvt_pk_bf16_f32 v222, v20, v21
    v_cvt_pk_bf16_f32 v223, v22, v23
    s_lshr_b32 s30, s95, 2
    v_lshrrev_b32 v248, 3, v0
    s_lshl_b32 s31, s3, 3
    v_add_u32 v248, s31, v248
    v_and_b32 v249, 3, v0
    v_lshlrev_b32 v250, 2, v249
    v_xor_b32 v250, v250, v248
    v_lshlrev_b32 v250, 4, v250
    v_lshl_add_u32 v250, v249, 10, v250
    v_bfe_u32 v249, v0, 2, 1
    s_lshl_b32 s31, s30, 1
    v_add_u32 v249, s31, v249
    v_mul_u32_u24 v251, 10240, v249
    v_add_u32 v251, v251, v250
    v_mul_u32_u24 v249, 40960, v249
    v_add_u32 v249, v249, v250
    s_lshl_b32 s31, s30, 7
    v_lshl_add_u32 v250, v248, 2, s31
    s_lshl_b32 s30, s30, 5
    s_add_u32 s30, s30, s92
    s_lshl_b32 s30, s30, 10
    s_lshl_b32 s31, s93, 7
    s_add_u32 s30, s30, s31
    v_lshlrev_b32 v248, 16, v248
    v_add_u32 v248, s30, v248
    v_and_b32 v252, 7, v0
    v_lshl_add_u32 v248, v252, 4, v248
    s_mul_i32 s30, s3, 10240
    s_add_u32 s30, s30, 4096
    v_lshlrev_b32 v225, 4, v0
    v_add_u32 v240, s30, v225
    v_xor_b32 v241, 64, v240
    v_xor_b32 v242, 128, v240
    v_xor_b32 v243, 192, v240
    v_and_b32 v225, 31, v0
    s_lshl_b32 s30, s66, 7
    v_lshl_add_u32 v244, v225, 2, s30
    s_waitcnt lgkmcnt(0)
    s_mov_b32 s44, s28
    s_mov_b32 s45, s29
    s_mov_b32 s46, 0x920000
    s_mov_b32 s47, 0x20000
    s_barrier
    ds_read_b64_tr_b16 v[32:33], v6 offset:0
    ds_read_b64_tr_b16 v[34:35], v6 offset:768
    ds_read_b128 v[16:19], v4 offset:0
    ds_read_b64_tr_b16 v[44:45], v6 offset:12288
    ds_read_b64_tr_b16 v[46:47], v6 offset:13056
    ds_read_b128 v[20:23], v4 offset:2048
    ds_read_b128 v[24:27], v4 offset:4096
    ds_read_b128 v[28:31], v4 offset:6144
P1_LOOPF:
    s_waitcnt lgkmcnt(3)
    v_mfma_f32_16x16x32_bf16 v[96:99], v[32:35], v[16:19], v[96:99]
    ds_read_b64_tr_b16 v[36:37], v7 offset:32
    ds_read_b64_tr_b16 v[38:39], v7 offset:800
    v_mfma_f32_16x16x32_bf16 v[100:103], v[44:47], v[16:19], v[100:103]
    ds_read_b64_tr_b16 v[48:49], v7 offset:12320
    ds_read_b64_tr_b16 v[50:51], v7 offset:13088
    s_waitcnt lgkmcnt(4)
    v_mfma_f32_16x16x32_bf16 v[120:123], v[32:35], v[20:23], v[120:123]
    ds_read_b64_tr_b16 v[40:41], v6 offset:64
    ds_read_b64_tr_b16 v[42:43], v6 offset:832
    v_mfma_f32_16x16x32_bf16 v[124:127], v[44:47], v[20:23], v[124:127]
    ds_read_b64_tr_b16 v[52:53], v6 offset:12352
    ds_read_b64_tr_b16 v[54:55], v6 offset:13120
    v_mfma_f32_16x16x32_bf16 v[144:147], v[32:35], v[24:27], v[144:147]
    ds_read_b64_tr_b16 v[72:73], v6 offset:6144
    v_mfma_f32_16x16x32_bf16 v[148:151], v[44:47], v[24:27], v[148:151]
    ds_read_b64_tr_b16 v[74:75], v6 offset:6912
    v_mfma_f32_16x16x32_bf16 v[168:171], v[32:35], v[28:31], v[168:171]
    ds_read_b128 v[56:59], v5 offset:0
    v_mfma_f32_16x16x32_bf16 v[172:175], v[44:47], v[28:31], v[172:175]
    ds_read_b64_tr_b16 v[84:85], v6 offset:18432
    s_waitcnt lgkmcnt(4)
    v_mfma_f32_16x16x32_bf16 v[104:107], v[36:39], v[16:19], v[104:107]
    ds_read_b64_tr_b16 v[86:87], v6 offset:19200
    v_mfma_f32_16x16x32_bf16 v[108:111], v[48:51], v[16:19], v[108:111]
    ds_read_b128 v[60:63], v5 offset:2048
    v_mfma_f32_16x16x32_bf16 v[128:131], v[36:39], v[20:23], v[128:131]
    ds_read_b128 v[64:67], v5 offset:4096
    v_mfma_f32_16x16x32_bf16 v[132:135], v[48:51], v[20:23], v[132:135]
    ds_read_b128 v[68:71], v5 offset:6144
    v_mfma_f32_16x16x32_bf16 v[152:155], v[36:39], v[24:27], v[152:155]
    ds_read_b64_tr_b16 v[76:77], v7 offset:6176
    s_add_u32 s68, s68, 1
    v_mfma_f32_16x16x32_bf16 v[156:159], v[48:51], v[24:27], v[156:159]
    ds_read_b64_tr_b16 v[78:79], v7 offset:6944
    s_and_b32 s30, s68, 3
    v_mfma_f32_16x16x32_bf16 v[176:179], v[36:39], v[28:31], v[176:179]
    ds_read_b64_tr_b16 v[88:89], v7 offset:18464
    s_cmp_eq_u32 s30, 0
    v_mfma_f32_16x16x32_bf16 v[180:183], v[48:51], v[28:31], v[180:183]
    ds_read_b64_tr_b16 v[90:91], v7 offset:19232
    s_cselect_b32 s30, s82, s83
    v_mfma_f32_16x16x32_bf16 v[112:115], v[40:43], v[16:19], v[112:115]
    ds_read_b64_tr_b16 v[80:81], v6 offset:6208
    v_mfma_f32_16x16x32_bf16 v[116:119], v[52:55], v[16:19], v[116:119]
    ds_read_b64_tr_b16 v[82:83], v6 offset:6976
    v_mfma_f32_16x16x32_bf16 v[136:139], v[40:43], v[20:23], v[136:139]
    ds_read_b64_tr_b16 v[92:93], v6 offset:18496
    v_mfma_f32_16x16x32_bf16 v[140:143], v[52:55], v[20:23], v[140:143]
    ds_read_b64_tr_b16 v[94:95], v6 offset:19264
    v_mfma_f32_16x16x32_bf16 v[160:163], v[40:43], v[24:27], v[160:163]
    v_add_u32 v4, s30, v4
    v_add_u32 v5, s30, v5
    v_mfma_f32_16x16x32_bf16 v[164:167], v[52:55], v[24:27], v[164:167]
    v_add_u32 v6, s30, v6
    v_add_u32 v7, s30, v7
    v_mfma_f32_16x16x32_bf16 v[184:187], v[40:43], v[28:31], v[184:187]
    s_cmp_eq_u32 s68, 8
    v_mfma_f32_16x16x32_bf16 v[188:191], v[52:55], v[28:31], v[188:191]
    s_waitcnt lgkmcnt(0)
    s_cbranch_scc1 P1_LASTF
    v_mfma_f32_16x16x32_bf16 v[96:99], v[72:75], v[56:59], v[96:99]
    s_cmp_eq_u32 s68, s73
    v_mfma_f32_16x16x32_bf16 v[100:103], v[84:87], v[56:59], v[100:103]
    s_cbranch_scc1 P1_PUB
P1_PUBR:
    v_mfma_f32_16x16x32_bf16 v[120:123], v[72:75], v[60:63], v[120:123]
    v_mfma_f32_16x16x32_bf16 v[124:127], v[84:87], v[60:63], v[124:127]
    v_mfma_f32_16x16x32_bf16 v[144:147], v[72:75], v[64:67], v[144:147]
    v_mfma_f32_16x16x32_bf16 v[148:151], v[84:87], v[64:67], v[148:151]
    v_mfma_f32_16x16x32_bf16 v[168:171], v[72:75], v[68:71], v[168:171]
    v_mfma_f32_16x16x32_bf16 v[172:175], v[84:87], v[68:71], v[172:175]
    v_mfma_f32_16x16x32_bf16 v[104:107], v[76:79], v[56:59], v[104:107]
    v_mfma_f32_16x16x32_bf16 v[108:111], v[88:91], v[56:59], v[108:111]
    v_mfma_f32_16x16x32_bf16 v[128:131], v[76:79], v[60:63], v[128:131]
    v_mfma_f32_16x16x32_bf16 v[132:135], v[88:91], v[60:63], v[132:135]
    v_mfma_f32_16x16x32_bf16 v[152:155], v[76:79], v[64:67], v[152:155]
    v_mfma_f32_16x16x32_bf16 v[156:159], v[88:91], v[64:67], v[156:159]
    s_barrier
    v_mfma_f32_16x16x32_bf16 v[176:179], v[76:79], v[68:71], v[176:179]
    ds_read_b64_tr_b16 v[32:33], v6 offset:0
    v_mfma_f32_16x16x32_bf16 v[180:183], v[88:91], v[68:71], v[180:183]
    ds_read_b64_tr_b16 v[34:35], v6 offset:768
    v_mfma_f32_16x16x32_bf16 v[112:115], v[80:83], v[56:59], v[112:115]
    ds_read_b128 v[16:19], v4 offset:0
    v_mfma_f32_16x16x32_bf16 v[116:119], v[92:95], v[56:59], v[116:119]
    ds_read_b64_tr_b16 v[44:45], v6 offset:12288
    v_mfma_f32_16x16x32_bf16 v[136:139], v[80:83], v[60:63], v[136:139]
    ds_read_b64_tr_b16 v[46:47], v6 offset:13056
    v_mfma_f32_16x16x32_bf16 v[140:143], v[92:95], v[60:63], v[140:143]
    ds_read_b128 v[20:23], v4 offset:2048
    v_mfma_f32_16x16x32_bf16 v[160:163], v[80:83], v[64:67], v[160:163]
    ds_read_b128 v[24:27], v4 offset:4096
    v_mfma_f32_16x16x32_bf16 v[164:167], v[92:95], v[64:67], v[164:167]
    ds_read_b128 v[28:31], v4 offset:6144
    v_mfma_f32_16x16x32_bf16 v[184:187], v[80:83], v[68:71], v[184:187]
    v_mfma_f32_16x16x32_bf16 v[188:191], v[92:95], v[68:71], v[188:191]
    s_branch P1_LOOPF
P1_PUB:
    s_mov_b32 s48, s26
    s_mov_b32 s49, s27
    s_mov_b32 s50, 0x100
    s_mov_b32 s51, 0x20000
    v_mov_b32 v12, 1
    s_and_b32 s30, s2, 7
    s_lshl_b32 s30, s30, 2
    s_mov_b64 exec, 1
    s_waitcnt vmcnt(0)
    s_setprio 3
    buffer_store_dword v12, off, s[48:51], s30 sc0 sc1
    s_setprio 0
    s_mov_b64 exec, -1
    s_branch P1_PUBR
P1_LASTF:
    v_mfma_f32_16x16x32_bf16 v[96:99], v[72:75], v[56:59], v[96:99]
    s_barrier
    v_mfma_f32_16x16x32_bf16 v[100:103], v[84:87], v[56:59], v[100:103]
    s_load_dwordx8 s[4:11], s[26:27], 0
    v_mfma_f32_16x16x32_bf16 v[120:123], v[72:75], v[60:63], v[120:123]
    s_waitcnt vmcnt(0)
    v_mfma_f32_16x16x32_bf16 v[124:127], v[84:87], v[60:63], v[124:127]
    v_mfma_f32_16x16x32_bf16 v[144:147], v[72:75], v[64:67], v[144:147]
    v_mfma_f32_16x16x32_bf16 v[148:151], v[84:87], v[64:67], v[148:151]
    v_mfma_f32_16x16x32_bf16 v[168:171], v[72:75], v[68:71], v[168:171]
    v_mfma_f32_16x16x32_bf16 v[172:175], v[84:87], v[68:71], v[172:175]
    v_mfma_f32_16x16x32_bf16 v[104:107], v[76:79], v[56:59], v[104:107]
    v_mfma_f32_16x16x32_bf16 v[108:111], v[88:91], v[56:59], v[108:111]
    v_mfma_f32_16x16x32_bf16 v[128:131], v[76:79], v[60:63], v[128:131]
    v_mfma_f32_16x16x32_bf16 v[132:135], v[88:91], v[60:63], v[132:135]
    v_mfma_f32_16x16x32_bf16 v[152:155], v[76:79], v[64:67], v[152:155]
    v_mfma_f32_16x16x32_bf16 v[156:159], v[88:91], v[64:67], v[156:159]
    v_mfma_f32_16x16x32_bf16 v[176:179], v[76:79], v[68:71], v[176:179]
    v_mfma_f32_16x16x32_bf16 v[180:183], v[88:91], v[68:71], v[180:183]
    v_mfma_f32_16x16x32_bf16 v[112:115], v[80:83], v[56:59], v[112:115]
    v_mfma_f32_16x16x32_bf16 v[116:119], v[92:95], v[56:59], v[116:119]
    v_mfma_f32_16x16x32_bf16 v[136:139], v[80:83], v[60:63], v[136:139]
    v_mfma_f32_16x16x32_bf16 v[140:143], v[92:95], v[60:63], v[140:143]
    v_mfma_f32_16x16x32_bf16 v[160:163], v[80:83], v[64:67], v[160:163]
    v_mfma_f32_16x16x32_bf16 v[164:167], v[92:95], v[64:67], v[164:167]
    v_mfma_f32_16x16x32_bf16 v[184:187], v[80:83], v[68:71], v[184:187]
    v_mfma_f32_16x16x32_bf16 v[188:191], v[92:95], v[68:71], v[188:191]
    v_pk_mul_f32 v[16:17], v[96:97], v[96:97]
    v_pk_mul_f32 v[18:19], v[98:99], v[98:99]
    v_pk_mul_f32 v[20:21], v[120:121], v[120:121]
    v_pk_mul_f32 v[22:23], v[122:123], v[122:123]
    v_pk_fma_f32 v[16:17], v[16:17], s[72:73], v[10:11] op_sel_hi:[1,0,0]
    v_pk_fma_f32 v[18:19], v[18:19], s[72:73], v[10:11] op_sel_hi:[1,0,0]
    v_pk_fma_f32 v[20:21], v[20:21], s[72:73], v[10:11] op_sel_hi:[1,0,0]
    v_pk_fma_f32 v[22:23], v[22:23], s[72:73], v[10:11] op_sel_hi:[1,0,0]
    v_pk_mul_f32 v[16:17], v[16:17], v[96:97]
    v_pk_mul_f32 v[18:19], v[18:19], v[98:99]
    v_pk_mul_f32 v[20:21], v[20:21], v[120:121]
    v_pk_mul_f32 v[22:23], v[22:23], v[122:123]
    v_exp_f32 v16, v16
    v_exp_f32 v17, v17
    v_pk_mul_f32 v[96:97], v[96:97], v[100:101]
    v_exp_f32 v18, v18
    v_exp_f32 v19, v19
    v_pk_mul_f32 v[98:99], v[98:99], v[102:103]
    v_exp_f32 v20, v20
    v_exp_f32 v21, v21
    v_pk_mul_f32 v[120:121], v[120:121], v[124:125]
    v_exp_f32 v22, v22
    v_exp_f32 v23, v23
    v_pk_mul_f32 v[122:123], v[122:123], v[126:127]
    v_pk_add_f32 v[16:17], v[16:17], 1.0 op_sel_hi:[1,0]
    v_pk_add_f32 v[18:19], v[18:19], 1.0 op_sel_hi:[1,0]
    v_pk_add_f32 v[20:21], v[20:21], 1.0 op_sel_hi:[1,0]
    v_pk_add_f32 v[22:23], v[22:23], 1.0 op_sel_hi:[1,0]
    v_rcp_f32 v16, v16
    v_rcp_f32 v17, v17
    v_rcp_f32 v18, v18
    v_rcp_f32 v19, v19
    v_rcp_f32 v20, v20
    v_rcp_f32 v21, v21
    v_rcp_f32 v22, v22
    v_rcp_f32 v23, v23
    v_pk_mul_f32 v[96:97], v[96:97], v[16:17]
    v_pk_mul_f32 v[98:99], v[98:99], v[18:19]
    v_pk_mul_f32 v[120:121], v[120:121], v[20:21]
    v_pk_mul_f32 v[122:123], v[122:123], v[22:23]
    v_cvt_pk_bf16_f32 v32, v96, v97
    v_cvt_pk_bf16_f32 v33, v98, v99
    v_cvt_pk_bf16_f32 v34, v120, v121
    v_cvt_pk_bf16_f32 v35, v122, v123
    s_nop 1
    v_permlane16_swap_b32 v32, v34
    v_permlane16_swap_b32 v33, v35
    v_pk_mul_f32 v[24:25], v[144:145], v[144:145]
    v_pk_mul_f32 v[26:27], v[146:147], v[146:147]
    v_pk_mul_f32 v[28:29], v[168:169], v[168:169]
    v_pk_mul_f32 v[30:31], v[170:171], v[170:171]
    v_pk_fma_f32 v[24:25], v[24:25], s[72:73], v[10:11] op_sel_hi:[1,0,0]
    v_pk_fma_f32 v[26:27], v[26:27], s[72:73], v[10:11] op_sel_hi:[1,0,0]
    v_pk_fma_f32 v[28:29], v[28:29], s[72:73], v[10:11] op_sel_hi:[1,0,0]
    v_pk_fma_f32 v[30:31], v[30:31], s[72:73], v[10:11] op_sel_hi:[1,0,0]
    v_pk_mul_f32 v[24:25], v[24:25], v[144:145]
    v_pk_mul_f32 v[26:27], v[26:27], v[146:147]
    v_pk_mul_f32 v[28:29], v[28:29], v[168:169]
    v_pk_mul_f32 v[30:31], v[30:31], v[170:171]
    v_exp_f32 v24, v24
    v_exp_f32 v25, v25
    v_pk_mul_f32 v[144:145], v[144:145], v[148:149]
    v_exp_f32 v26, v26
    v_exp_f32 v27, v27
    v_pk_mul_f32 v[146:147], v[146:147], v[150:151]
    v_exp_f32 v28, v28
    v_exp_f32 v29, v29
    v_pk_mul_f32 v[168:169], v[168:169], v[172:173]
    v_exp_f32 v30, v30
    v_exp_f32 v31, v31
    v_pk_mul_f32 v[170:171], v[170:171], v[174:175]
    v_pk_add_f32 v[24:25], v[24:25], 1.0 op_sel_hi:[1,0]
    v_pk_add_f32 v[26:27], v[26:27], 1.0 op_sel_hi:[1,0]
    v_pk_add_f32 v[28:29], v[28:29], 1.0 op_sel_hi:[1,0]
    v_pk_add_f32 v[30:31], v[30:31], 1.0 op_sel_hi:[1,0]
    v_rcp_f32 v24, v24
    v_rcp_f32 v25, v25
    v_rcp_f32 v26, v26
    v_rcp_f32 v27, v27
    v_rcp_f32 v28, v28
    v_rcp_f32 v29, v29
    v_rcp_f32 v30, v30
    v_rcp_f32 v31, v31
    v_pk_mul_f32 v[144:145], v[144:145], v[24:25]
    v_pk_mul_f32 v[146:147], v[146:147], v[26:27]
    v_pk_mul_f32 v[168:169], v[168:169], v[28:29]
    v_pk_mul_f32 v[170:171], v[170:171], v[30:31]
    v_cvt_pk_bf16_f32 v36, v144, v145
    v_cvt_pk_bf16_f32 v37, v146, v147
    v_cvt_pk_bf16_f32 v38, v168, v169
    v_cvt_pk_bf16_f32 v39, v170, v171
    s_nop 1
    v_permlane16_swap_b32 v36, v38
    v_permlane16_swap_b32 v37, v39
    v_pk_mul_f32 v[16:17], v[104:105], v[104:105]
    v_pk_mul_f32 v[18:19], v[106:107], v[106:107]
    v_pk_mul_f32 v[20:21], v[128:129], v[128:129]
    v_pk_mul_f32 v[22:23], v[130:131], v[130:131]
    v_pk_fma_f32 v[16:17], v[16:17], s[72:73], v[10:11] op_sel_hi:[1,0,0]
    v_pk_fma_f32 v[18:19], v[18:19], s[72:73], v[10:11] op_sel_hi:[1,0,0]
    v_pk_fma_f32 v[20:21], v[20:21], s[72:73], v[10:11] op_sel_hi:[1,0,0]
    v_pk_fma_f32 v[22:23], v[22:23], s[72:73], v[10:11] op_sel_hi:[1,0,0]
    v_pk_mul_f32 v[16:17], v[16:17], v[104:105]
    v_pk_mul_f32 v[18:19], v[18:19], v[106:107]
    v_pk_mul_f32 v[20:21], v[20:21], v[128:129]
    v_pk_mul_f32 v[22:23], v[22:23], v[130:131]
    v_exp_f32 v16, v16
    v_exp_f32 v17, v17
    v_pk_mul_f32 v[104:105], v[104:105], v[108:109]
    v_exp_f32 v18, v18
    v_exp_f32 v19, v19
    v_pk_mul_f32 v[106:107], v[106:107], v[110:111]
    v_exp_f32 v20, v20
    v_exp_f32 v21, v21
    v_pk_mul_f32 v[128:129], v[128:129], v[132:133]
    v_exp_f32 v22, v22
    v_exp_f32 v23, v23
    v_pk_mul_f32 v[130:131], v[130:131], v[134:135]
    v_pk_add_f32 v[16:17], v[16:17], 1.0 op_sel_hi:[1,0]
    v_pk_add_f32 v[18:19], v[18:19], 1.0 op_sel_hi:[1,0]
    v_pk_add_f32 v[20:21], v[20:21], 1.0 op_sel_hi:[1,0]
    v_pk_add_f32 v[22:23], v[22:23], 1.0 op_sel_hi:[1,0]
    v_rcp_f32 v16, v16
    v_rcp_f32 v17, v17
    v_rcp_f32 v18, v18
    v_rcp_f32 v19, v19
    v_rcp_f32 v20, v20
    v_rcp_f32 v21, v21
    v_rcp_f32 v22, v22
    v_rcp_f32 v23, v23
    v_pk_mul_f32 v[104:105], v[104:105], v[16:17]
    v_pk_mul_f32 v[106:107], v[106:107], v[18:19]
    v_pk_mul_f32 v[128:129], v[128:129], v[20:21]
    v_pk_mul_f32 v[130:131], v[130:131], v[22:23]
    v_cvt_pk_bf16_f32 v40, v104, v105
    v_cvt_pk_bf16_f32 v41, v106, v107
    v_cvt_pk_bf16_f32 v42, v128, v129
    v_cvt_pk_bf16_f32 v43, v130, v131
    s_nop 1
    v_permlane16_swap_b32 v40, v42
    v_permlane16_swap_b32 v41, v43
    v_pk_mul_f32 v[24:25], v[152:153], v[152:153]
    v_pk_mul_f32 v[26:27], v[154:155], v[154:155]
    v_pk_mul_f32 v[28:29], v[176:177], v[176:177]
    v_pk_mul_f32 v[30:31], v[178:179], v[178:179]
    v_pk_fma_f32 v[24:25], v[24:25], s[72:73], v[10:11] op_sel_hi:[1,0,0]
    v_pk_fma_f32 v[26:27], v[26:27], s[72:73], v[10:11] op_sel_hi:[1,0,0]
    v_pk_fma_f32 v[28:29], v[28:29], s[72:73], v[10:11] op_sel_hi:[1,0,0]
    v_pk_fma_f32 v[30:31], v[30:31], s[72:73], v[10:11] op_sel_hi:[1,0,0]
    v_pk_mul_f32 v[24:25], v[24:25], v[152:153]
    v_pk_mul_f32 v[26:27], v[26:27], v[154:155]
    v_pk_mul_f32 v[28:29], v[28:29], v[176:177]
    v_pk_mul_f32 v[30:31], v[30:31], v[178:179]
    v_exp_f32 v24, v24
    v_exp_f32 v25, v25
    v_pk_mul_f32 v[152:153], v[152:153], v[156:157]
    v_exp_f32 v26, v26
    v_exp_f32 v27, v27
    v_pk_mul_f32 v[154:155], v[154:155], v[158:159]
    v_exp_f32 v28, v28
    v_exp_f32 v29, v29
    v_pk_mul_f32 v[176:177], v[176:177], v[180:181]
    v_exp_f32 v30, v30
    v_exp_f32 v31, v31
    v_pk_mul_f32 v[178:179], v[178:179], v[182:183]
    v_pk_add_f32 v[24:25], v[24:25], 1.0 op_sel_hi:[1,0]
    v_pk_add_f32 v[26:27], v[26:27], 1.0 op_sel_hi:[1,0]
    v_pk_add_f32 v[28:29], v[28:29], 1.0 op_sel_hi:[1,0]
    v_pk_add_f32 v[30:31], v[30:31], 1.0 op_sel_hi:[1,0]
    v_rcp_f32 v24, v24
    v_rcp_f32 v25, v25
    v_rcp_f32 v26, v26
    v_rcp_f32 v27, v27
    v_rcp_f32 v28, v28
    v_rcp_f32 v29, v29
    v_rcp_f32 v30, v30
    v_rcp_f32 v31, v31
    v_pk_mul_f32 v[152:153], v[152:153], v[24:25]
    v_pk_mul_f32 v[154:155], v[154:155], v[26:27]
    v_pk_mul_f32 v[176:177], v[176:177], v[28:29]
    v_pk_mul_f32 v[178:179], v[178:179], v[30:31]
    v_cvt_pk_bf16_f32 v44, v152, v153
    v_cvt_pk_bf16_f32 v45, v154, v155
    v_cvt_pk_bf16_f32 v46, v176, v177
    v_cvt_pk_bf16_f32 v47, v178, v179
    s_nop 1
    v_permlane16_swap_b32 v44, v46
    v_permlane16_swap_b32 v45, v47
    v_pk_mul_f32 v[16:17], v[112:113], v[112:113]
    v_pk_mul_f32 v[18:19], v[114:115], v[114:115]
    v_pk_mul_f32 v[20:21], v[136:137], v[136:137]
    v_pk_mul_f32 v[22:23], v[138:139], v[138:139]
    v_pk_fma_f32 v[16:17], v[16:17], s[72:73], v[10:11] op_sel_hi:[1,0,0]
    v_pk_fma_f32 v[18:19], v[18:19], s[72:73], v[10:11] op_sel_hi:[1,0,0]
    v_pk_fma_f32 v[20:21], v[20:21], s[72:73], v[10:11] op_sel_hi:[1,0,0]
    v_pk_fma_f32 v[22:23], v[22:23], s[72:73], v[10:11] op_sel_hi:[1,0,0]
    v_pk_mul_f32 v[16:17], v[16:17], v[112:113]
    v_pk_mul_f32 v[18:19], v[18:19], v[114:115]
    v_pk_mul_f32 v[20:21], v[20:21], v[136:137]
    v_pk_mul_f32 v[22:23], v[22:23], v[138:139]
    v_exp_f32 v16, v16
    v_exp_f32 v17, v17
    v_pk_mul_f32 v[112:113], v[112:113], v[116:117]
    v_exp_f32 v18, v18
    v_exp_f32 v19, v19
    v_pk_mul_f32 v[114:115], v[114:115], v[118:119]
    v_exp_f32 v20, v20
    v_exp_f32 v21, v21
    v_pk_mul_f32 v[136:137], v[136:137], v[140:141]
    v_exp_f32 v22, v22
    v_exp_f32 v23, v23
    v_pk_mul_f32 v[138:139], v[138:139], v[142:143]
    v_pk_add_f32 v[16:17], v[16:17], 1.0 op_sel_hi:[1,0]
    v_pk_add_f32 v[18:19], v[18:19], 1.0 op_sel_hi:[1,0]
    v_pk_add_f32 v[20:21], v[20:21], 1.0 op_sel_hi:[1,0]
    v_pk_add_f32 v[22:23], v[22:23], 1.0 op_sel_hi:[1,0]
    v_rcp_f32 v16, v16
    v_rcp_f32 v17, v17
    v_rcp_f32 v18, v18
    v_rcp_f32 v19, v19
    v_rcp_f32 v20, v20
    v_rcp_f32 v21, v21
    v_rcp_f32 v22, v22
    v_rcp_f32 v23, v23
    v_pk_mul_f32 v[112:113], v[112:113], v[16:17]
    v_pk_mul_f32 v[114:115], v[114:115], v[18:19]
    v_pk_mul_f32 v[136:137], v[136:137], v[20:21]
    v_pk_mul_f32 v[138:139], v[138:139], v[22:23]
    v_cvt_pk_bf16_f32 v48, v112, v113
    v_cvt_pk_bf16_f32 v49, v114, v115
    v_cvt_pk_bf16_f32 v50, v136, v137
    v_cvt_pk_bf16_f32 v51, v138, v139
    s_nop 1
    v_permlane16_swap_b32 v48, v50
    v_permlane16_swap_b32 v49, v51
    v_pk_mul_f32 v[24:25], v[160:161], v[160:161]
    v_pk_mul_f32 v[26:27], v[162:163], v[162:163]
    v_pk_mul_f32 v[28:29], v[184:185], v[184:185]
    v_pk_mul_f32 v[30:31], v[186:187], v[186:187]
    v_pk_fma_f32 v[24:25], v[24:25], s[72:73], v[10:11] op_sel_hi:[1,0,0]
    v_pk_fma_f32 v[26:27], v[26:27], s[72:73], v[10:11] op_sel_hi:[1,0,0]
    v_pk_fma_f32 v[28:29], v[28:29], s[72:73], v[10:11] op_sel_hi:[1,0,0]
    v_pk_fma_f32 v[30:31], v[30:31], s[72:73], v[10:11] op_sel_hi:[1,0,0]
    v_pk_mul_f32 v[24:25], v[24:25], v[160:161]
    v_pk_mul_f32 v[26:27], v[26:27], v[162:163]
    v_pk_mul_f32 v[28:29], v[28:29], v[184:185]
    v_pk_mul_f32 v[30:31], v[30:31], v[186:187]
    v_exp_f32 v24, v24
    v_exp_f32 v25, v25
    v_pk_mul_f32 v[160:161], v[160:161], v[164:165]
    v_exp_f32 v26, v26
    v_exp_f32 v27, v27
    v_pk_mul_f32 v[162:163], v[162:163], v[166:167]
    v_exp_f32 v28, v28
    v_exp_f32 v29, v29
    v_pk_mul_f32 v[184:185], v[184:185], v[188:189]
    v_exp_f32 v30, v30
    v_exp_f32 v31, v31
    v_pk_mul_f32 v[186:187], v[186:187], v[190:191]
    v_pk_add_f32 v[24:25], v[24:25], 1.0 op_sel_hi:[1,0]
    v_pk_add_f32 v[26:27], v[26:27], 1.0 op_sel_hi:[1,0]
    v_pk_add_f32 v[28:29], v[28:29], 1.0 op_sel_hi:[1,0]
    v_pk_add_f32 v[30:31], v[30:31], 1.0 op_sel_hi:[1,0]
    v_rcp_f32 v24, v24
    v_rcp_f32 v25, v25
    v_rcp_f32 v26, v26
    v_rcp_f32 v27, v27
    v_rcp_f32 v28, v28
    v_rcp_f32 v29, v29
    v_rcp_f32 v30, v30
    v_rcp_f32 v31, v31
    v_pk_mul_f32 v[160:161], v[160:161], v[24:25]
    v_pk_mul_f32 v[162:163], v[162:163], v[26:27]
    v_pk_mul_f32 v[184:185], v[184:185], v[28:29]
    v_pk_mul_f32 v[186:187], v[186:187], v[30:31]
    v_cvt_pk_bf16_f32 v52, v160, v161
    v_cvt_pk_bf16_f32 v53, v162, v163
    v_cvt_pk_bf16_f32 v54, v184, v185
    v_cvt_pk_bf16_f32 v55, v186, v187
    s_nop 1
    v_permlane16_swap_b32 v52, v54
    v_permlane16_swap_b32 v53, v55
    s_setprio 3
    buffer_store_dwordx4 v[32:35], v3, s[44:47], s70 offen offset:0 sc1
    buffer_store_dwordx4 v[36:39], v3, s[44:47], s71 offen offset:0 sc1
    buffer_store_dwordx4 v[40:43], v3, s[44:47], s70 offen offset:1024 sc1
    buffer_store_dwordx4 v[44:47], v3, s[44:47], s71 offen offset:1024 sc1
    buffer_store_dwordx4 v[48:51], v3, s[44:47], s70 offen offset:2048 sc1
    buffer_store_dwordx4 v[52:55], v3, s[44:47], s71 offen offset:2048 sc1
    s_setprio 0
    s_waitcnt lgkmcnt(0)
    s_and_b64 s[4:5], s[4:5], s[6:7]
    s_and_b64 s[8:9], s[8:9], s[10:11]
    s_and_b64 s[4:5], s[4:5], s[8:9]
    s_and_b32 s4, s4, s5
    s_cbranch_scc1 NOKF
    s_mov_b32 s48, s26
    s_mov_b32 s49, s27
    s_mov_b32 s50, 0x100
    s_mov_b32 s51, 0x20000
    s_mov_b32 s61, 0
    v_lshlrev_b32 v13, 2, v0
    s_mov_b64 exec, 0xff
NLF:
    v_mov_b32 v12, 0
    buffer_atomic_add v12, v13, s[48:51], 0 offen sc0 sc1
    s_add_u32 s61, s61, 1
    s_cmp_gt_u32 s61, 400000
    s_waitcnt vmcnt(0)
    s_cbranch_scc1 NXF
    v_cmp_eq_u32 vcc, 0, v12
    s_cbranch_vccnz NLF
NXF:
    s_mov_b64 exec, -1
NOKF:
    s_mul_i32 s61, s69, 47
    s_lshr_b32 s61, s61, 10
    s_add_u32 s31, s69, 2
    s_mul_i32 s31, s31, 47
    s_lshr_b32 s31, s31, 10
    s_cmp_eq_u32 s31, s61
    s_cselect_b32 s64, 1, 3
    s_and_b32 s31, s56, 7
    s_lshl_b32 s31, s31, 3
    s_add_u32 s61, s61, s31
    s_lshl_b32 s31, s66, 2
    s_add_u32 s61, s61, s31
    s_lshl_b32 s30, s61, 7
    s_add_u32 s30, s30, 0x910000
    v_mov_b32 v12, 1
    v_lshlrev_b32 v13, 7, v0
    s_waitcnt vmcnt(0)
    s_mov_b32 exec_lo, s64
    s_mov_b32 exec_hi, 0
    s_setprio 3
    buffer_atomic_add v12, v13, s[44:47], s30 offen sc1
    s_setprio 0
    s_mov_b64 exec, -1
    s_branch P2_CONS
P1_CSP:
    v_lshrrev_b32 v2, 5, v0
    v_and_b32 v12, 31, v0
    v_bfe_u32 v4, v0, 1, 3
    v_xor_b32 v4, v4, v2
    v_lshlrev_b32 v4, 4, v4
    v_lshl_add_u32 v4, v12, 7, v4
    v_xor_b32 v5, 32, v4
    v_xor_b32 v6, 64, v4
    v_xor_b32 v7, 0x60, v4
    v_lshrrev_b32 v3, 2, v1
    v_lshl_add_u32 v3, v2, 3, v3
    v_bfe_u32 v14, v0, 4, 1
    v_bfe_u32 v8, v0, 3, 2
    v_xor_b32 v8, s3, v8
    v_lshlrev_b32 v8, 5, v8
    v_lshl_add_u32 v8, v3, 7, v8
    v_lshl_add_u32 v8, v11, 3, v8
    v_lshl_add_u32 v8, v14, 13, v8
    v_add_u32 v8, 16384, v8
    v_lshlrev_b32 v9, 5, v3
    v_lshl_add_u32 v9, v11, 3, v9
    v_mul_u32_u24 v3, 2176, v14
    v_add_u32 v9, v9, v3
    v_add_u32 v9, 32768, v9
    v_xor_b32 v3, 0x80, v9
    v_and_b32 v14, 1, v0
    v_mul_u32_u24 v14, 0x8000, v14
    v_lshl_or_b32 v14, v14, 16, v14
    v_mov_b32 v112, 0
    v_mov_b32 v113, 0
    v_mov_b32 v114, 0
    v_mov_b32 v115, 0
    v_mov_b32 v116, 0
    v_mov_b32 v117, 0
    v_mov_b32 v118, 0
    v_mov_b32 v119, 0
    v_mov_b32 v120, 0
    v_mov_b32 v121, 0
    v_mov_b32 v122, 0
    v_mov_b32 v123, 0
    v_mov_b32 v124, 0
    v_mov_b32 v125, 0
    v_mov_b32 v126, 0
    v_mov_b32 v127, 0
    v_mov_b32 v128, 0
    v_mov_b32 v129, 0
    v_mov_b32 v130, 0
    v_mov_b32 v131, 0
    v_mov_b32 v132, 0
    v_mov_b32 v133, 0
    v_mov_b32 v134, 0
    v_mov_b32 v135, 0
    v_mov_b32 v136, 0
    v_mov_b32 v137, 0
    v_mov_b32 v138, 0
    v_mov_b32 v139, 0
    v_mov_b32 v140, 0
    v_mov_b32 v141, 0
    v_mov_b32 v142, 0
    v_mov_b32 v143, 0
    v_mov_b32 v144, 0
    v_mov_b32 v145, 0
    v_mov_b32 v146, 0
    v_mov_b32 v147, 0
    v_mov_b32 v148, 0
    v_mov_b32 v149, 0
    v_mov_b32 v150, 0
    v_mov_b32 v151, 0
    v_mov_b32 v152, 0
    v_mov_b32 v153, 0
    v_mov_b32 v154, 0
    v_mov_b32 v155, 0
    v_mov_b32 v156, 0
    v_mov_b32 v157, 0
    v_mov_b32 v158, 0
    v_mov_b32 v159, 0
    v_mov_b32 v160, 0
    v_mov_b32 v161, 0
    v_mov_b32 v162, 0
    v_mov_b32 v163, 0
    v_mov_b32 v164, 0
    v_mov_b32 v165, 0
    v_mov_b32 v166, 0
    v_mov_b32 v167, 0
    v_mov_b32 v168, 0
    v_mov_b32 v169, 0
    v_mov_b32 v170, 0
    v_mov_b32 v171, 0
    v_mov_b32 v172, 0
    v_mov_b32 v173, 0
    v_mov_b32 v174, 0
    v_mov_b32 v175, 0
    v_mov_b32 v176, 0
    v_mov_b32 v177, 0
    v_mov_b32 v178, 0
    v_mov_b32 v179, 0
    v_mov_b32 v180, 0
    v_mov_b32 v181, 0
    v_mov_b32 v182, 0
    v_mov_b32 v183, 0
    v_mov_b32 v184, 0
    v_mov_b32 v185, 0
    v_mov_b32 v186, 0
    v_mov_b32 v187, 0
    v_mov_b32 v188, 0
    v_mov_b32 v189, 0
    v_mov_b32 v190, 0
    v_mov_b32 v191, 0
    v_mov_b32 v192, 0
    v_mov_b32 v193, 0
    v_mov_b32 v194, 0
    v_mov_b32 v195, 0
    v_mov_b32 v196, 0
    v_mov_b32 v197, 0
    v_mov_b32 v198, 0
    v_mov_b32 v199, 0
    v_mov_b32 v200, 0
    v_mov_b32 v201, 0
    v_mov_b32 v202, 0
    v_mov_b32 v203, 0
    v_mov_b32 v204, 0
    v_mov_b32 v205, 0
    v_mov_b32 v206, 0
    v_mov_b32 v207, 0
    v_mov_b32 v208, 0
    v_mov_b32 v209, 0
    v_mov_b32 v210, 0
    v_mov_b32 v211, 0
    v_mov_b32 v212, 0
    v_mov_b32 v213, 0
    v_mov_b32 v214, 0
    v_mov_b32 v215, 0
    v_mov_b32 v216, 0
    v_mov_b32 v217, 0
    v_mov_b32 v218, 0
    v_mov_b32 v219, 0
    v_mov_b32 v220, 0
    v_mov_b32 v221, 0
    v_mov_b32 v222, 0
    v_mov_b32 v223, 0
    v_mov_b32 v224, 0
    v_mov_b32 v225, 0
    v_mov_b32 v226, 0
    v_mov_b32 v227, 0
    v_mov_b32 v228, 0
    v_mov_b32 v229, 0
    v_mov_b32 v230, 0
    v_mov_b32 v231, 0
    v_mov_b32 v232, 0
    v_mov_b32 v233, 0
    v_mov_b32 v234, 0
    v_mov_b32 v235, 0
    v_mov_b32 v236, 0
    v_mov_b32 v237, 0
    v_mov_b32 v238, 0
    v_mov_b32 v239, 0
    v_mov_b32 v240, 0
    v_mov_b32 v241, 0
    v_mov_b32 v242, 0
    v_mov_b32 v243, 0
    v_mov_b32 v244, 0
    v_mov_b32 v245, 0
    v_mov_b32 v246, 0
    v_mov_b32 v247, 0
    v_mov_b32 v248, 0
    v_mov_b32 v249, 0
    v_mov_b32 v250, 0
    v_mov_b32 v251, 0
    v_mov_b32 v252, 0
    v_mov_b32 v253, 0
    v_mov_b32 v254, 0
    v_mov_b32 v255, 0
    v_cvt_f32_u32 v16, v12
    v_mul_f32 v16, 0x3d000000, v16
    v_lshlrev_b32 v18, 2, v2
    v_cvt_f32_u32 v18, v18
    v_add_f32 v19, 0x00000000, v18
    v_mul_f32 v19, v19, v16
    v_cos_f32 v20, v19
    v_sin_f32 v28, v19
    v_add_f32 v19, 0x3f800000, v18
    v_mul_f32 v19, v19, v16
    v_cos_f32 v21, v19
    v_sin_f32 v29, v19
    v_add_f32 v19, 0x40000000, v18
    v_mul_f32 v19, v19, v16
    v_cos_f32 v22, v19
    v_sin_f32 v30, v19
    v_add_f32 v19, 0x40400000, v18
    v_mul_f32 v19, v19, v16
    v_cos_f32 v23, v19
    v_sin_f32 v31, v19
    v_add_f32 v19, 0x41000000, v18
    v_mul_f32 v19, v19, v16
    v_cos_f32 v24, v19
    v_sin_f32 v32, v19
    v_add_f32 v19, 0x41100000, v18
    v_mul_f32 v19, v19, v16
    v_cos_f32 v25, v19
    v_sin_f32 v33, v19
    v_add_f32 v19, 0x41200000, v18
    v_mul_f32 v19, v19, v16
    v_cos_f32 v26, v19
    v_sin_f32 v34, v19
    v_add_f32 v19, 0x41300000, v18
    v_mul_f32 v19, v19, v16
    v_cos_f32 v27, v19
    v_sin_f32 v35, v19
    s_nop 0
    v_cvt_pk_bf16_f32 v40, v20, v21
    v_cvt_pk_bf16_f32 v48, v28, v29
    v_cvt_pk_bf16_f32 v41, v22, v23
    v_cvt_pk_bf16_f32 v49, v30, v31
    v_cvt_pk_bf16_f32 v42, v24, v25
    v_cvt_pk_bf16_f32 v50, v32, v33
    v_cvt_pk_bf16_f32 v43, v26, v27
    v_cvt_pk_bf16_f32 v51, v34, v35
    v_add_f32 v19, 0x41800000, v18
    v_mul_f32 v19, v19, v16
    v_cos_f32 v20, v19
    v_sin_f32 v28, v19
    v_add_f32 v19, 0x41880000, v18
    v_mul_f32 v19, v19, v16
    v_cos_f32 v21, v19
    v_sin_f32 v29, v19
    v_add_f32 v19, 0x41900000, v18
    v_mul_f32 v19, v19, v16
    v_cos_f32 v22, v19
    v_sin_f32 v30, v19
    v_add_f32 v19, 0x41980000, v18
    v_mul_f32 v19, v19, v16
    v_cos_f32 v23, v19
    v_sin_f32 v31, v19
    v_add_f32 v19, 0x41c00000, v18
    v_mul_f32 v19, v19, v16
    v_cos_f32 v24, v19
    v_sin_f32 v32, v19
    v_add_f32 v19, 0x41c80000, v18
    v_mul_f32 v19, v19, v16
    v_cos_f32 v25, v19
    v_sin_f32 v33, v19
    v_add_f32 v19, 0x41d00000, v18
    v_mul_f32 v19, v19, v16
    v_cos_f32 v26, v19
    v_sin_f32 v34, v19
    v_add_f32 v19, 0x41d80000, v18
    v_mul_f32 v19, v19, v16
    v_cos_f32 v27, v19
    v_sin_f32 v35, v19
    s_nop 0
    v_cvt_pk_bf16_f32 v44, v20, v21
    v_cvt_pk_bf16_f32 v52, v28, v29
    v_cvt_pk_bf16_f32 v45, v22, v23
    v_cvt_pk_bf16_f32 v53, v30, v31
    v_cvt_pk_bf16_f32 v46, v24, v25
    v_cvt_pk_bf16_f32 v54, v32, v33
    v_cvt_pk_bf16_f32 v47, v26, v27
    v_cvt_pk_bf16_f32 v55, v34, v35
    v_lshlrev_b32 v11, 4, v0
    v_add_u32 v11, 159744, v11
    ds_write_b128 v11, v[40:43] offset:0
    ds_write_b128 v11, v[44:47] offset:1024
    ds_write_b128 v11, v[48:51] offset:2048
    ds_write_b128 v11, v[52:55] offset:3072
    s_waitcnt lgkmcnt(0)
    s_mov_b32 s44, s28
    s_mov_b32 s45, s29
    s_mov_b32 s46, 0x920000
    s_mov_b32 s47, 0x20000
    s_waitcnt vmcnt(0) lgkmcnt(0)
    v_mov_b32 v13, 0
    s_barrier
    ds_read_b64_tr_b16 v[48:49], v8 offset:0
    ds_read_b64_tr_b16 v[50:51], v8 offset:512
    ds_read_b128 v[16:19], v4 offset:0
    ds_read_b128 v[20:23], v4 offset:4096
    ds_read_b128 v[24:27], v4 offset:8192
    ds_read_b128 v[28:31], v4 offset:12288
    ds_read_b64_tr_b16 v[56:57], v9 offset:0
    ds_read_b64_tr_b16 v[58:59], v3 offset:0
    ds_read_b64_tr_b16 v[52:53], v8 offset:2048
    ds_read_b64_tr_b16 v[54:55], v8 offset:2560
    ds_read_b128 v[32:35], v5 offset:0
    ds_read_b128 v[36:39], v5 offset:4096
    ds_read_b128 v[40:43], v5 offset:8192
    ds_read_b128 v[44:47], v5 offset:12288
    ds_read_b64_tr_b16 v[60:61], v9 offset:512
    ds_read_b64_tr_b16 v[62:63], v3 offset:512
    s_cmp_eq_u32 s3, 1
    s_cbranch_scc1 P1_LOOPS1
    s_cmp_eq_u32 s3, 2
    s_cbranch_scc1 P1_LOOPS2
    s_cmp_eq_u32 s3, 3
    s_cbranch_scc1 P1_LOOPS3
P1_LOOPS0:
    s_waitcnt lgkmcnt(8)
    v_mfma_f32_32x32x16_bf16 v[112:127], v[16:19], v[48:51], v[112:127]
    ds_read_b64_tr_b16 v[96:97], v8 offset:4096
    ds_read_b64_tr_b16 v[98:99], v8 offset:4608
    s_add_u32 s68, s68, 1
    v_mfma_f32_32x32x16_bf16 v[128:143], v[20:23], v[48:51], v[128:143]
    ds_read_b128 v[64:67], v6 offset:0
    ds_read_b128 v[68:71], v6 offset:4096
    s_and_b32 s30, s68, 3
    v_mfma_f32_32x32x16_bf16 v[144:159], v[24:27], v[48:51], v[144:159]
    ds_read_b128 v[72:75], v6 offset:8192
    ds_read_b128 v[76:79], v6 offset:12288
    s_waitcnt lgkmcnt(12)
    v_xor_b32 v52, v13, v52
    v_xor_b32 v53, v13, v53
    v_mfma_f32_32x32x16_bf16 v[160:175], v[28:31], v[48:51], v[160:175]
    ds_read_b64_tr_b16 v[104:105], v9 offset:1024
    v_xor_b32 v54, v13, v54
    v_xor_b32 v55, v13, v55
    s_cmp_eq_u32 s30, 0
    v_mfma_f32_32x32x16_bf16 v[240:255], v[56:59], v[16:19], v[240:255]
    ds_read_b64_tr_b16 v[106:107], v3 offset:1024
    s_cselect_b32 s30, s82, s83
    v_add_u32 v4, s30, v4
    s_waitcnt lgkmcnt(8)
    v_mfma_f32_32x32x16_bf16 v[112:127], v[32:35], v[52:55], v[112:127]
    ds_read_b64_tr_b16 v[100:101], v8 offset:6144
    ds_read_b64_tr_b16 v[102:103], v8 offset:6656
    v_add_u32 v5, s30, v5
    v_mfma_f32_32x32x16_bf16 v[128:143], v[36:39], v[52:55], v[128:143]
    ds_read_b128 v[80:83], v7 offset:0
    ds_read_b128 v[84:87], v7 offset:4096
    v_add_u32 v8, s30, v8
    v_mfma_f32_32x32x16_bf16 v[144:159], v[40:43], v[52:55], v[144:159]
    ds_read_b128 v[88:91], v7 offset:8192
    ds_read_b128 v[92:95], v7 offset:12288
    s_waitcnt lgkmcnt(12)
    v_xor_b32 v96, v13, v96
    v_xor_b32 v97, v13, v97
    v_mfma_f32_32x32x16_bf16 v[160:175], v[44:47], v[52:55], v[160:175]
    ds_read_b64_tr_b16 v[108:109], v9 offset:1536
    v_xor_b32 v98, v13, v98
    v_xor_b32 v99, v13, v99
    v_add_u32 v6, s30, v6
    v_mfma_f32_32x32x16_bf16 v[240:255], v[60:63], v[32:35], v[240:255]
    ds_read_b64_tr_b16 v[110:111], v3 offset:1536
    v_add_u32 v9, s30, v9
    v_add_u32 v3, s30, v3
    s_cmp_eq_u32 s68, 8
    s_cbranch_scc1 P1_LASTS0
    s_waitcnt lgkmcnt(8)
    v_mfma_f32_32x32x16_bf16 v[176:191], v[64:67], v[96:99], v[176:191]
    s_barrier
    ds_read_b64_tr_b16 v[48:49], v8 offset:0
    ds_read_b64_tr_b16 v[50:51], v8 offset:512
    v_mfma_f32_32x32x16_bf16 v[192:207], v[68:71], v[96:99], v[192:207]
    ds_read_b128 v[16:19], v4 offset:0
    ds_read_b128 v[20:23], v4 offset:4096
    v_add_u32 v7, s30, v7
    v_mfma_f32_32x32x16_bf16 v[208:223], v[72:75], v[96:99], v[208:223]
    ds_read_b128 v[24:27], v4 offset:8192
    ds_read_b128 v[28:31], v4 offset:12288
    s_waitcnt lgkmcnt(12)
    v_xor_b32 v100, v13, v100
    v_xor_b32 v101, v13, v101
    v_mfma_f32_32x32x16_bf16 v[224:239], v[76:79], v[96:99], v[224:239]
    ds_read_b64_tr_b16 v[56:57], v9 offset:0
    v_xor_b32 v102, v13, v102
    v_xor_b32 v103, v13, v103
    s_cmp_ge_u32 s68, 4
    v_mfma_f32_32x32x16_bf16 v[240:255], v[104:107], v[64:67], v[240:255]
    ds_read_b64_tr_b16 v[58:59], v3 offset:0
    s_cselect_b32 s31, -1, 0
    v_and_b32 v13, s31, v14
    s_waitcnt lgkmcnt(8)
    v_mfma_f32_32x32x16_bf16 v[176:191], v[80:83], v[100:103], v[176:191]
    ds_read_b64_tr_b16 v[52:53], v8 offset:2048
    ds_read_b64_tr_b16 v[54:55], v8 offset:2560
    v_mfma_f32_32x32x16_bf16 v[192:207], v[84:87], v[100:103], v[192:207]
    ds_read_b128 v[32:35], v5 offset:0
    ds_read_b128 v[36:39], v5 offset:4096
    v_mfma_f32_32x32x16_bf16 v[208:223], v[88:91], v[100:103], v[208:223]
    ds_read_b128 v[40:43], v5 offset:8192
    ds_read_b128 v[44:47], v5 offset:12288
    s_waitcnt lgkmcnt(12)
    v_xor_b32 v48, v13, v48
    v_xor_b32 v49, v13, v49
    v_mfma_f32_32x32x16_bf16 v[224:239], v[92:95], v[100:103], v[224:239]
    ds_read_b64_tr_b16 v[60:61], v9 offset:512
    v_xor_b32 v50, v13, v50
    v_xor_b32 v51, v13, v51
    v_mfma_f32_32x32x16_bf16 v[240:255], v[108:111], v[80:83], v[240:255]
    ds_read_b64_tr_b16 v[62:63], v3 offset:512
    s_branch P1_LOOPS0
P1_LASTS0:
    s_waitcnt lgkmcnt(8)
    v_mfma_f32_32x32x16_bf16 v[176:191], v[64:67], v[96:99], v[176:191]
    ds_read_b128 v[16:19], v11 offset:0
    ds_read_b128 v[20:23], v11 offset:1024
    v_mfma_f32_32x32x16_bf16 v[192:207], v[68:71], v[96:99], v[192:207]
    ds_read_b128 v[24:27], v11 offset:2048
    ds_read_b128 v[28:31], v11 offset:3072
    s_lshl_b32 s30, s56, 2
    s_add_u32 s30, s30, s3
    s_mul_i32 s30, s30, 86
    s_add_u32 s30, s30, s59
    v_mfma_f32_32x32x16_bf16 v[208:223], v[72:75], v[96:99], v[208:223]
    s_waitcnt lgkmcnt(10)
    v_xor_b32 v100, v13, v100
    v_xor_b32 v101, v13, v101
    v_mfma_f32_32x32x16_bf16 v[224:239], v[76:79], v[96:99], v[224:239]
    v_xor_b32 v102, v13, v102
    v_xor_b32 v103, v13, v103
    v_mfma_f32_32x32x16_bf16 v[240:255], v[104:107], v[64:67], v[240:255]
    s_add_u32 s30, s30, 84
    s_lshl_b32 s70, s30, 10
    s_mul_i32 s69, s56, 4224
    s_add_u32 s69, s69, 0x600000
    s_waitcnt lgkmcnt(0)
    v_mfma_f32_32x32x16_bf16 v[176:191], v[80:83], v[100:103], v[176:191]
    s_barrier
    s_load_dwordx8 s[4:11], s[26:27], 0
    v_mfma_f32_32x32x16_bf16 v[192:207], v[84:87], v[100:103], v[192:207]
    v_xor_b32 v32, 0x80008000, v16
    v_xor_b32 v33, 0x80008000, v17
    v_xor_b32 v34, 0x80008000, v18
    v_xor_b32 v35, 0x80008000, v19
    v_mfma_f32_32x32x16_bf16 v[208:223], v[88:91], v[100:103], v[208:223]
    v_xor_b32 v36, 0x80008000, v20
    v_xor_b32 v37, 0x80008000, v21
    v_xor_b32 v38, 0x80008000, v22
    v_xor_b32 v39, 0x80008000, v23
    v_mfma_f32_32x32x16_bf16 v[224:239], v[92:95], v[100:103], v[224:239]
    v_mfma_f32_32x32x16_bf16 v[240:255], v[108:111], v[80:83], v[240:255]
    s_branch P1_LASTS
P1_LOOPS1:
    s_waitcnt lgkmcnt(8)
    v_mfma_f32_32x32x16_bf16 v[112:127], v[16:19], v[48:51], v[112:127]
    ds_read_b64_tr_b16 v[96:97], v8 offset:4096
    ds_read_b64_tr_b16 v[98:99], v8 offset:4608
    s_add_u32 s68, s68, 1
    v_mfma_f32_32x32x16_bf16 v[128:143], v[20:23], v[48:51], v[128:143]
    ds_read_b128 v[64:67], v6 offset:0
    ds_read_b128 v[68:71], v6 offset:4096
    s_and_b32 s30, s68, 3
    v_mfma_f32_32x32x16_bf16 v[144:159], v[24:27], v[48:51], v[144:159]
    ds_read_b128 v[72:75], v6 offset:8192
    ds_read_b128 v[76:79], v6 offset:12288
    s_waitcnt lgkmcnt(12)
    v_xor_b32 v52, v13, v52
    v_xor_b32 v53, v13, v53
    v_mfma_f32_32x32x16_bf16 v[160:175], v[28:31], v[48:51], v[160:175]
    ds_read_b64_tr_b16 v[104:105], v9 offset:1024
    v_xor_b32 v54, v13, v54
    v_xor_b32 v55, v13, v55
    s_cmp_eq_u32 s30, 0
    v_mfma_f32_32x32x16_bf16 v[240:255], v[56:59], v[20:23], v[240:255]
    ds_read_b64_tr_b16 v[106:107], v3 offset:1024
    s_cselect_b32 s30, s82, s83
    v_add_u32 v4, s30, v4
    s_waitcnt lgkmcnt(8)
    v_mfma_f32_32x32x16_bf16 v[112:127], v[32:35], v[52:55], v[112:127]
    ds_read_b64_tr_b16 v[100:101], v8 offset:6144
    ds_read_b64_tr_b16 v[102:103], v8 offset:6656
    v_add_u32 v5, s30, v5
    v_mfma_f32_32x32x16_bf16 v[128:143], v[36:39], v[52:55], v[128:143]
    ds_read_b128 v[80:83], v7 offset:0
    ds_read_b128 v[84:87], v7 offset:4096
    v_add_u32 v8, s30, v8
    v_mfma_f32_32x32x16_bf16 v[144:159], v[40:43], v[52:55], v[144:159]
    ds_read_b128 v[88:91], v7 offset:8192
    ds_read_b128 v[92:95], v7 offset:12288
    s_waitcnt lgkmcnt(12)
    v_xor_b32 v96, v13, v96
    v_xor_b32 v97, v13, v97
    v_mfma_f32_32x32x16_bf16 v[160:175], v[44:47], v[52:55], v[160:175]
    ds_read_b64_tr_b16 v[108:109], v9 offset:1536
    v_xor_b32 v98, v13, v98
    v_xor_b32 v99, v13, v99
    v_add_u32 v6, s30, v6
    v_mfma_f32_32x32x16_bf16 v[240:255], v[60:63], v[36:39], v[240:255]
    ds_read_b64_tr_b16 v[110:111], v3 offset:1536
    v_add_u32 v9, s30, v9
    v_add_u32 v3, s30, v3
    s_cmp_eq_u32 s68, 8
    s_cbranch_scc1 P1_LASTS1
    s_waitcnt lgkmcnt(8)
    v_mfma_f32_32x32x16_bf16 v[176:191], v[64:67], v[96:99], v[176:191]
    s_barrier
    ds_read_b64_tr_b16 v[48:49], v8 offset:0
    ds_read_b64_tr_b16 v[50:51], v8 offset:512
    v_mfma_f32_32x32x16_bf16 v[192:207], v[68:71], v[96:99], v[192:207]
    ds_read_b128 v[16:19], v4 offset:0
    ds_read_b128 v[20:23], v4 offset:4096
    v_add_u32 v7, s30, v7
    v_mfma_f32_32x32x16_bf16 v[208:223], v[72:75], v[96:99], v[208:223]
    ds_read_b128 v[24:27], v4 offset:8192
    ds_read_b128 v[28:31], v4 offset:12288
    s_waitcnt lgkmcnt(12)
    v_xor_b32 v100, v13, v100
    v_xor_b32 v101, v13, v101
    v_mfma_f32_32x32x16_bf16 v[224:239], v[76:79], v[96:99], v[224:239]
    ds_read_b64_tr_b16 v[56:57], v9 offset:0
    v_xor_b32 v102, v13, v102
    v_xor_b32 v103, v13, v103
    s_cmp_ge_u32 s68, 4
    v_mfma_f32_32x32x16_bf16 v[240:255], v[104:107], v[68:71], v[240:255]
    ds_read_b64_tr_b16 v[58:59], v3 offset:0
    s_cselect_b32 s31, -1, 0
    v_and_b32 v13, s31, v14
    s_waitcnt lgkmcnt(8)
    v_mfma_f32_32x32x16_bf16 v[176:191], v[80:83], v[100:103], v[176:191]
    ds_read_b64_tr_b16 v[52:53], v8 offset:2048
    ds_read_b64_tr_b16 v[54:55], v8 offset:2560
    v_mfma_f32_32x32x16_bf16 v[192:207], v[84:87], v[100:103], v[192:207]
    ds_read_b128 v[32:35], v5 offset:0
    ds_read_b128 v[36:39], v5 offset:4096
    v_mfma_f32_32x32x16_bf16 v[208:223], v[88:91], v[100:103], v[208:223]
    ds_read_b128 v[40:43], v5 offset:8192
    ds_read_b128 v[44:47], v5 offset:12288
    s_waitcnt lgkmcnt(12)
    v_xor_b32 v48, v13, v48
    v_xor_b32 v49, v13, v49
    v_mfma_f32_32x32x16_bf16 v[224:239], v[92:95], v[100:103], v[224:239]
    ds_read_b64_tr_b16 v[60:61], v9 offset:512
    v_xor_b32 v50, v13, v50
    v_xor_b32 v51, v13, v51
    v_mfma_f32_32x32x16_bf16 v[240:255], v[108:111], v[84:87], v[240:255]
    ds_read_b64_tr_b16 v[62:63], v3 offset:512
    s_branch P1_LOOPS1
P1_LASTS1:
    s_waitcnt lgkmcnt(8)
    v_mfma_f32_32x32x16_bf16 v[176:191], v[64:67], v[96:99], v[176:191]
    ds_read_b128 v[16:19], v11 offset:0
    ds_read_b128 v[20:23], v11 offset:1024
    v_mfma_f32_32x32x16_bf16 v[192:207], v[68:71], v[96:99], v[192:207]
    ds_read_b128 v[24:27], v11 offset:2048
    ds_read_b128 v[28:31], v11 offset:3072
    s_lshl_b32 s30, s56, 2
    s_add_u32 s30, s30, s3
    s_mul_i32 s30, s30, 86
    s_add_u32 s30, s30, s59
    v_mfma_f32_32x32x16_bf16 v[208:223], v[72:75], v[96:99], v[208:223]
    s_waitcnt lgkmcnt(10)
    v_xor_b32 v100, v13, v100
    v_xor_b32 v101, v13, v101
    v_mfma_f32_32x32x16_bf16 v[224:239], v[76:79], v[96:99], v[224:239]
    v_xor_b32 v102, v13, v102
    v_xor_b32 v103, v13, v103
    v_mfma_f32_32x32x16_bf16 v[240:255], v[104:107], v[68:71], v[240:255]
    s_add_u32 s30, s30, 84
    s_lshl_b32 s70, s30, 10
    s_mul_i32 s69, s56, 4224
    s_add_u32 s69, s69, 0x600000
    s_waitcnt lgkmcnt(0)
    v_mfma_f32_32x32x16_bf16 v[176:191], v[80:83], v[100:103], v[176:191]
    s_barrier
    s_load_dwordx8 s[4:11], s[26:27], 0
    v_mfma_f32_32x32x16_bf16 v[192:207], v[84:87], v[100:103], v[192:207]
    v_xor_b32 v32, 0x80008000, v16
    v_xor_b32 v33, 0x80008000, v17
    v_xor_b32 v34, 0x80008000, v18
    v_xor_b32 v35, 0x80008000, v19
    v_mfma_f32_32x32x16_bf16 v[208:223], v[88:91], v[100:103], v[208:223]
    v_xor_b32 v36, 0x80008000, v20
    v_xor_b32 v37, 0x80008000, v21
    v_xor_b32 v38, 0x80008000, v22
    v_xor_b32 v39, 0x80008000, v23
    v_mfma_f32_32x32x16_bf16 v[224:239], v[92:95], v[100:103], v[224:239]
    v_mfma_f32_32x32x16_bf16 v[240:255], v[108:111], v[84:87], v[240:255]
    s_branch P1_LASTS
P1_LOOPS2:
    s_waitcnt lgkmcnt(8)
    v_mfma_f32_32x32x16_bf16 v[112:127], v[16:19], v[48:51], v[112:127]
    ds_read_b64_tr_b16 v[96:97], v8 offset:4096
    ds_read_b64_tr_b16 v[98:99], v8 offset:4608
    s_add_u32 s68, s68, 1
    v_mfma_f32_32x32x16_bf16 v[128:143], v[20:23], v[48:51], v[128:143]
    ds_read_b128 v[64:67], v6 offset:0
    ds_read_b128 v[68:71], v6 offset:4096
    s_and_b32 s30, s68, 3
    v_mfma_f32_32x32x16_bf16 v[144:159], v[24:27], v[48:51], v[144:159]
    ds_read_b128 v[72:75], v6 offset:8192
    ds_read_b128 v[76:79], v6 offset:12288
    s_waitcnt lgkmcnt(12)
    v_xor_b32 v52, v13, v52
    v_xor_b32 v53, v13, v53
    v_mfma_f32_32x32x16_bf16 v[160:175], v[28:31], v[48:51], v[160:175]
    ds_read_b64_tr_b16 v[104:105], v9 offset:1024
    v_xor_b32 v54, v13, v54
    v_xor_b32 v55, v13, v55
    s_cmp_eq_u32 s30, 0
    v_mfma_f32_32x32x16_bf16 v[240:255], v[56:59], v[24:27], v[240:255]
    ds_read_b64_tr_b16 v[106:107], v3 offset:1024
    s_cselect_b32 s30, s82, s83
    v_add_u32 v4, s30, v4
    s_waitcnt lgkmcnt(8)
    v_mfma_f32_32x32x16_bf16 v[112:127], v[32:35], v[52:55], v[112:127]
    ds_read_b64_tr_b16 v[100:101], v8 offset:6144
    ds_read_b64_tr_b16 v[102:103], v8 offset:6656
    v_add_u32 v5, s30, v5
    v_mfma_f32_32x32x16_bf16 v[128:143], v[36:39], v[52:55], v[128:143]
    ds_read_b128 v[80:83], v7 offset:0
    ds_read_b128 v[84:87], v7 offset:4096
    v_add_u32 v8, s30, v8
    v_mfma_f32_32x32x16_bf16 v[144:159], v[40:43], v[52:55], v[144:159]
    ds_read_b128 v[88:91], v7 offset:8192
    ds_read_b128 v[92:95], v7 offset:12288
    s_waitcnt lgkmcnt(12)
    v_xor_b32 v96, v13, v96
    v_xor_b32 v97, v13, v97
    v_mfma_f32_32x32x16_bf16 v[160:175], v[44:47], v[52:55], v[160:175]
    ds_read_b64_tr_b16 v[108:109], v9 offset:1536
    v_xor_b32 v98, v13, v98
    v_xor_b32 v99, v13, v99
    v_add_u32 v6, s30, v6
    v_mfma_f32_32x32x16_bf16 v[240:255], v[60:63], v[40:43], v[240:255]
    ds_read_b64_tr_b16 v[110:111], v3 offset:1536
    v_add_u32 v9, s30, v9
    v_add_u32 v3, s30, v3
    s_cmp_eq_u32 s68, 8
    s_cbranch_scc1 P1_LASTS2
    s_waitcnt lgkmcnt(8)
    v_mfma_f32_32x32x16_bf16 v[176:191], v[64:67], v[96:99], v[176:191]
    s_barrier
    ds_read_b64_tr_b16 v[48:49], v8 offset:0
    ds_read_b64_tr_b16 v[50:51], v8 offset:512
    v_mfma_f32_32x32x16_bf16 v[192:207], v[68:71], v[96:99], v[192:207]
    ds_read_b128 v[16:19], v4 offset:0
    ds_read_b128 v[20:23], v4 offset:4096
    v_add_u32 v7, s30, v7
    v_mfma_f32_32x32x16_bf16 v[208:223], v[72:75], v[96:99], v[208:223]
    ds_read_b128 v[24:27], v4 offset:8192
    ds_read_b128 v[28:31], v4 offset:12288
    s_waitcnt lgkmcnt(12)
    v_xor_b32 v100, v13, v100
    v_xor_b32 v101, v13, v101
    v_mfma_f32_32x32x16_bf16 v[224:239], v[76:79], v[96:99], v[224:239]
    ds_read_b64_tr_b16 v[56:57], v9 offset:0
    v_xor_b32 v102, v13, v102
    v_xor_b32 v103, v13, v103
    s_cmp_ge_u32 s68, 4
    v_mfma_f32_32x32x16_bf16 v[240:255], v[104:107], v[72:75], v[240:255]
    ds_read_b64_tr_b16 v[58:59], v3 offset:0
    s_cselect_b32 s31, -1, 0
    v_and_b32 v13, s31, v14
    s_waitcnt lgkmcnt(8)
    v_mfma_f32_32x32x16_bf16 v[176:191], v[80:83], v[100:103], v[176:191]
    ds_read_b64_tr_b16 v[52:53], v8 offset:2048
    ds_read_b64_tr_b16 v[54:55], v8 offset:2560
    v_mfma_f32_32x32x16_bf16 v[192:207], v[84:87], v[100:103], v[192:207]
    ds_read_b128 v[32:35], v5 offset:0
    ds_read_b128 v[36:39], v5 offset:4096
    v_mfma_f32_32x32x16_bf16 v[208:223], v[88:91], v[100:103], v[208:223]
    ds_read_b128 v[40:43], v5 offset:8192
    ds_read_b128 v[44:47], v5 offset:12288
    s_waitcnt lgkmcnt(12)
    v_xor_b32 v48, v13, v48
    v_xor_b32 v49, v13, v49
    v_mfma_f32_32x32x16_bf16 v[224:239], v[92:95], v[100:103], v[224:239]
    ds_read_b64_tr_b16 v[60:61], v9 offset:512
    v_xor_b32 v50, v13, v50
    v_xor_b32 v51, v13, v51
    v_mfma_f32_32x32x16_bf16 v[240:255], v[108:111], v[88:91], v[240:255]
    ds_read_b64_tr_b16 v[62:63], v3 offset:512
    s_branch P1_LOOPS2
P1_LASTS2:
    s_waitcnt lgkmcnt(8)
    v_mfma_f32_32x32x16_bf16 v[176:191], v[64:67], v[96:99], v[176:191]
    ds_read_b128 v[16:19], v11 offset:0
    ds_read_b128 v[20:23], v11 offset:1024
    v_mfma_f32_32x32x16_bf16 v[192:207], v[68:71], v[96:99], v[192:207]
    ds_read_b128 v[24:27], v11 offset:2048
    ds_read_b128 v[28:31], v11 offset:3072
    s_lshl_b32 s30, s56, 2
    s_add_u32 s30, s30, s3
    s_mul_i32 s30, s30, 86
    s_add_u32 s30, s30, s59
    v_mfma_f32_32x32x16_bf16 v[208:223], v[72:75], v[96:99], v[208:223]
    s_waitcnt lgkmcnt(10)
    v_xor_b32 v100, v13, v100
    v_xor_b32 v101, v13, v101
    v_mfma_f32_32x32x16_bf16 v[224:239], v[76:79], v[96:99], v[224:239]
    v_xor_b32 v102, v13, v102
    v_xor_b32 v103, v13, v103
    v_mfma_f32_32x32x16_bf16 v[240:255], v[104:107], v[72:75], v[240:255]
    s_add_u32 s30, s30, 84
    s_lshl_b32 s70, s30, 10
    s_mul_i32 s69, s56, 4224
    s_add_u32 s69, s69, 0x600000
    s_waitcnt lgkmcnt(0)
    v_mfma_f32_32x32x16_bf16 v[176:191], v[80:83], v[100:103], v[176:191]
    s_barrier
    s_load_dwordx8 s[4:11], s[26:27], 0
    v_mfma_f32_32x32x16_bf16 v[192:207], v[84:87], v[100:103], v[192:207]
    v_xor_b32 v32, 0x80008000, v16
    v_xor_b32 v33, 0x80008000, v17
    v_xor_b32 v34, 0x80008000, v18
    v_xor_b32 v35, 0x80008000, v19
    v_mfma_f32_32x32x16_bf16 v[208:223], v[88:91], v[100:103], v[208:223]
    v_xor_b32 v36, 0x80008000, v20
    v_xor_b32 v37, 0x80008000, v21
    v_xor_b32 v38, 0x80008000, v22
    v_xor_b32 v39, 0x80008000, v23
    v_mfma_f32_32x32x16_bf16 v[224:239], v[92:95], v[100:103], v[224:239]
    v_mfma_f32_32x32x16_bf16 v[240:255], v[108:111], v[88:91], v[240:255]
    s_branch P1_LASTS
P1_LOOPS3:
    s_waitcnt lgkmcnt(8)
    v_mfma_f32_32x32x16_bf16 v[112:127], v[16:19], v[48:51], v[112:127]
    ds_read_b64_tr_b16 v[96:97], v8 offset:4096
    ds_read_b64_tr_b16 v[98:99], v8 offset:4608
    s_add_u32 s68, s68, 1
    v_mfma_f32_32x32x16_bf16 v[128:143], v[20:23], v[48:51], v[128:143]
    ds_read_b128 v[64:67], v6 offset:0
    ds_read_b128 v[68:71], v6 offset:4096
    s_and_b32 s30, s68, 3
    v_mfma_f32_32x32x16_bf16 v[144:159], v[24:27], v[48:51], v[144:159]
    ds_read_b128 v[72:75], v6 offset:8192
    ds_read_b128 v[76:79], v6 offset:12288
    s_waitcnt lgkmcnt(12)
    v_xor_b32 v52, v13, v52
    v_xor_b32 v53, v13, v53
    v_mfma_f32_32x32x16_bf16 v[160:175], v[28:31], v[48:51], v[160:175]
    ds_read_b64_tr_b16 v[104:105], v9 offset:1024
    v_xor_b32 v54, v13, v54
    v_xor_b32 v55, v13, v55
    s_cmp_eq_u32 s30, 0
    v_mfma_f32_32x32x16_bf16 v[240:255], v[56:59], v[28:31], v[240:255]
    ds_read_b64_tr_b16 v[106:107], v3 offset:1024
    s_cselect_b32 s30, s82, s83
    v_add_u32 v4, s30, v4
    s_waitcnt lgkmcnt(8)
    v_mfma_f32_32x32x16_bf16 v[112:127], v[32:35], v[52:55], v[112:127]
    ds_read_b64_tr_b16 v[100:101], v8 offset:6144
    ds_read_b64_tr_b16 v[102:103], v8 offset:6656
    v_add_u32 v5, s30, v5
    v_mfma_f32_32x32x16_bf16 v[128:143], v[36:39], v[52:55], v[128:143]
    ds_read_b128 v[80:83], v7 offset:0
    ds_read_b128 v[84:87], v7 offset:4096
    v_add_u32 v8, s30, v8
    v_mfma_f32_32x32x16_bf16 v[144:159], v[40:43], v[52:55], v[144:159]
    ds_read_b128 v[88:91], v7 offset:8192
    ds_read_b128 v[92:95], v7 offset:12288
    s_waitcnt lgkmcnt(12)
    v_xor_b32 v96, v13, v96
    v_xor_b32 v97, v13, v97
    v_mfma_f32_32x32x16_bf16 v[160:175], v[44:47], v[52:55], v[160:175]
    ds_read_b64_tr_b16 v[108:109], v9 offset:1536
    v_xor_b32 v98, v13, v98
    v_xor_b32 v99, v13, v99
    v_add_u32 v6, s30, v6
    v_mfma_f32_32x32x16_bf16 v[240:255], v[60:63], v[44:47], v[240:255]
    ds_read_b64_tr_b16 v[110:111], v3 offset:1536
    v_add_u32 v9, s30, v9
    v_add_u32 v3, s30, v3
    s_cmp_eq_u32 s68, 8
    s_cbranch_scc1 P1_LASTS3
    s_waitcnt lgkmcnt(8)
    v_mfma_f32_32x32x16_bf16 v[176:191], v[64:67], v[96:99], v[176:191]
    s_barrier
    ds_read_b64_tr_b16 v[48:49], v8 offset:0
    ds_read_b64_tr_b16 v[50:51], v8 offset:512
    v_mfma_f32_32x32x16_bf16 v[192:207], v[68:71], v[96:99], v[192:207]
    ds_read_b128 v[16:19], v4 offset:0
    ds_read_b128 v[20:23], v4 offset:4096
    v_add_u32 v7, s30, v7
    v_mfma_f32_32x32x16_bf16 v[208:223], v[72:75], v[96:99], v[208:223]
    ds_read_b128 v[24:27], v4 offset:8192
    ds_read_b128 v[28:31], v4 offset:12288
    s_waitcnt lgkmcnt(12)
    v_xor_b32 v100, v13, v100
    v_xor_b32 v101, v13, v101
    v_mfma_f32_32x32x16_bf16 v[224:239], v[76:79], v[96:99], v[224:239]
    ds_read_b64_tr_b16 v[56:57], v9 offset:0
    v_xor_b32 v102, v13, v102
    v_xor_b32 v103, v13, v103
    s_cmp_ge_u32 s68, 4
    v_mfma_f32_32x32x16_bf16 v[240:255], v[104:107], v[76:79], v[240:255]
    ds_read_b64_tr_b16 v[58:59], v3 offset:0
    s_cselect_b32 s31, -1, 0
    v_and_b32 v13, s31, v14
    s_waitcnt lgkmcnt(8)
    v_mfma_f32_32x32x16_bf16 v[176:191], v[80:83], v[100:103], v[176:191]
    ds_read_b64_tr_b16 v[52:53], v8 offset:2048
    ds_read_b64_tr_b16 v[54:55], v8 offset:2560
    v_mfma_f32_32x32x16_bf16 v[192:207], v[84:87], v[100:103], v[192:207]
    ds_read_b128 v[32:35], v5 offset:0
    ds_read_b128 v[36:39], v5 offset:4096
    v_mfma_f32_32x32x16_bf16 v[208:223], v[88:91], v[100:103], v[208:223]
    ds_read_b128 v[40:43], v5 offset:8192
    ds_read_b128 v[44:47], v5 offset:12288
    s_waitcnt lgkmcnt(12)
    v_xor_b32 v48, v13, v48
    v_xor_b32 v49, v13, v49
    v_mfma_f32_32x32x16_bf16 v[224:239], v[92:95], v[100:103], v[224:239]
    ds_read_b64_tr_b16 v[60:61], v9 offset:512
    v_xor_b32 v50, v13, v50
    v_xor_b32 v51, v13, v51
    v_mfma_f32_32x32x16_bf16 v[240:255], v[108:111], v[92:95], v[240:255]
    ds_read_b64_tr_b16 v[62:63], v3 offset:512
    s_branch P1_LOOPS3
P1_LASTS3:
    s_waitcnt lgkmcnt(8)
    v_mfma_f32_32x32x16_bf16 v[176:191], v[64:67], v[96:99], v[176:191]
    ds_read_b128 v[16:19], v11 offset:0
    ds_read_b128 v[20:23], v11 offset:1024
    v_mfma_f32_32x32x16_bf16 v[192:207], v[68:71], v[96:99], v[192:207]
    ds_read_b128 v[24:27], v11 offset:2048
    ds_read_b128 v[28:31], v11 offset:3072
    s_lshl_b32 s30, s56, 2
    s_add_u32 s30, s30, s3
    s_mul_i32 s30, s30, 86
    s_add_u32 s30, s30, s59
    v_mfma_f32_32x32x16_bf16 v[208:223], v[72:75], v[96:99], v[208:223]
    s_waitcnt lgkmcnt(10)
    v_xor_b32 v100, v13, v100
    v_xor_b32 v101, v13, v101
    v_mfma_f32_32x32x16_bf16 v[224:239], v[76:79], v[96:99], v[224:239]
    v_xor_b32 v102, v13, v102
    v_xor_b32 v103, v13, v103
    v_mfma_f32_32x32x16_bf16 v[240:255], v[104:107], v[76:79], v[240:255]
    s_add_u32 s30, s30, 84
    s_lshl_b32 s70, s30, 10
    s_mul_i32 s69, s56, 4224
    s_add_u32 s69, s69, 0x600000
    s_waitcnt lgkmcnt(0)
    v_mfma_f32_32x32x16_bf16 v[176:191], v[80:83], v[100:103], v[176:191]
    s_barrier
    s_load_dwordx8 s[4:11], s[26:27], 0
    v_mfma_f32_32x32x16_bf16 v[192:207], v[84:87], v[100:103], v[192:207]
    v_xor_b32 v32, 0x80008000, v16
    v_xor_b32 v33, 0x80008000, v17
    v_xor_b32 v34, 0x80008000, v18
    v_xor_b32 v35, 0x80008000, v19
    v_mfma_f32_32x32x16_bf16 v[208:223], v[88:91], v[100:103], v[208:223]
    v_xor_b32 v36, 0x80008000, v20
    v_xor_b32 v37, 0x80008000, v21
    v_xor_b32 v38, 0x80008000, v22
    v_xor_b32 v39, 0x80008000, v23
    v_mfma_f32_32x32x16_bf16 v[224:239], v[92:95], v[100:103], v[224:239]
    v_mfma_f32_32x32x16_bf16 v[240:255], v[108:111], v[92:95], v[240:255]
P1_LASTS:
    v_lshlrev_b32 v3, 4, v0
    s_lshl_b32 s30, s59, 6
    s_lshl_b32 s31, s3, 4
    s_add_u32 s30, s30, s31
    v_bfe_u32 v5, v0, 4, 1
    v_lshl_add_u32 v4, v5, 7, v1
    v_add_u32 v4, s30, v4
    s_mov_b32 s31, 270336
    v_mul_lo_u32 v6, v2, s31
    v_lshl_add_u32 v4, v4, 4, v6
    v_mul_u32_u24 v5, 0x8000, v5
    v_lshl_or_b32 v5, v5, 16, v5
    v_mov_b32 v6, -1
    v_pk_mul_f32 v[72:73], v[240:241], v[240:241]
    v_pk_mul_f32 v[74:75], v[242:243], v[242:243]
    v_pk_mul_f32 v[76:77], v[244:245], v[244:245]
    v_pk_mul_f32 v[78:79], v[246:247], v[246:247]
    v_pk_fma_f32 v[72:73], v[72:73], s[72:73], v[10:11] op_sel_hi:[1,0,0]
    v_pk_fma_f32 v[74:75], v[74:75], s[72:73], v[10:11] op_sel_hi:[1,0,0]
    v_pk_fma_f32 v[76:77], v[76:77], s[72:73], v[10:11] op_sel_hi:[1,0,0]
    v_pk_fma_f32 v[78:79], v[78:79], s[72:73], v[10:11] op_sel_hi:[1,0,0]
    v_pk_mul_f32 v[72:73], v[72:73], v[240:241]
    v_pk_mul_f32 v[74:75], v[74:75], v[242:243]
    v_pk_mul_f32 v[76:77], v[76:77], v[244:245]
    v_pk_mul_f32 v[78:79], v[78:79], v[246:247]
    v_exp_f32 v72, v72
    v_exp_f32 v73, v73
    v_pk_mul_f32 v[240:241], v[240:241], v[248:249]
    v_exp_f32 v74, v74
    v_exp_f32 v75, v75
    v_pk_mul_f32 v[242:243], v[242:243], v[250:251]
    v_exp_f32 v76, v76
    v_exp_f32 v77, v77
    v_pk_mul_f32 v[244:245], v[244:245], v[252:253]
    v_exp_f32 v78, v78
    v_exp_f32 v79, v79
    v_pk_mul_f32 v[246:247], v[246:247], v[254:255]
    v_pk_add_f32 v[72:73], v[72:73], 1.0 op_sel_hi:[1,0]
    v_pk_add_f32 v[74:75], v[74:75], 1.0 op_sel_hi:[1,0]
    v_pk_add_f32 v[76:77], v[76:77], 1.0 op_sel_hi:[1,0]
    v_pk_add_f32 v[78:79], v[78:79], 1.0 op_sel_hi:[1,0]
    v_rcp_f32 v72, v72
    v_rcp_f32 v73, v73
    v_rcp_f32 v74, v74
    v_rcp_f32 v75, v75
    v_rcp_f32 v76, v76
    v_rcp_f32 v77, v77
    v_rcp_f32 v78, v78
    v_rcp_f32 v79, v79
    v_pk_mul_f32 v[240:241], v[240:241], v[72:73]
    v_pk_mul_f32 v[242:243], v[242:243], v[74:75]
    v_pk_mul_f32 v[244:245], v[244:245], v[76:77]
    v_pk_mul_f32 v[246:247], v[246:247], v[78:79]
    v_cvt_pk_bf16_f32 v100, v240, v241
    v_cvt_pk_bf16_f32 v101, v242, v243
    v_cvt_pk_bf16_f32 v102, v244, v245
    v_cvt_pk_bf16_f32 v103, v246, v247
    s_nop 1
    v_permlane32_swap_b32 v100, v102
    v_permlane32_swap_b32 v101, v103
    s_setprio 3
    buffer_store_dwordx4 v[100:103], v3, s[44:47], s70 offen sc1
    s_setprio 0
    s_cmp_lg_u32 s30, 0
    s_cbranch_scc1 P1_NOX
    v_cmp_ne_u32 vcc, 0, v1
    s_mov_b32 s31, 67584
    v_mul_lo_u32 v7, v0, s31
    v_cndmask_b32 v6, 0, v6, vcc
    v_cvt_pk_bf16_f32 v80, v112, v113
    v_cvt_pk_bf16_f32 v81, v114, v115
    v_cvt_pk_bf16_f32 v82, v116, v117
    v_cvt_pk_bf16_f32 v83, v118, v119
    v_cvt_pk_bf16_f32 v84, v120, v121
    v_cvt_pk_bf16_f32 v85, v122, v123
    v_cvt_pk_bf16_f32 v86, v124, v125
    v_cvt_pk_bf16_f32 v87, v126, v127
    v_cvt_pk_bf16_f32 v88, v176, v177
    v_cvt_pk_bf16_f32 v89, v178, v179
    v_cvt_pk_bf16_f32 v90, v180, v181
    v_cvt_pk_bf16_f32 v91, v182, v183
    v_cvt_pk_bf16_f32 v92, v184, v185
    v_cvt_pk_bf16_f32 v93, v186, v187
    v_cvt_pk_bf16_f32 v94, v188, v189
    v_cvt_pk_bf16_f32 v95, v190, v191
    v_cvt_pk_bf16_f32 v72, v128, v129
    v_cvt_pk_bf16_f32 v73, v130, v131
    v_cvt_pk_bf16_f32 v74, v132, v133
    v_cvt_pk_bf16_f32 v75, v134, v135
    v_cvt_pk_bf16_f32 v76, v136, v137
    v_cvt_pk_bf16_f32 v77, v138, v139
    v_cvt_pk_bf16_f32 v78, v140, v141
    v_cvt_pk_bf16_f32 v79, v142, v143
    v_mov_b32_dpp v80, v72 row_shr:1 row_mask:0xa bank_mask:0x1
    v_mov_b32_dpp v81, v73 row_shr:1 row_mask:0xa bank_mask:0x1
    v_mov_b32_dpp v82, v74 row_shr:1 row_mask:0xa bank_mask:0x1
    v_mov_b32_dpp v83, v75 row_shr:1 row_mask:0xa bank_mask:0x1
    v_mov_b32_dpp v84, v76 row_shr:1 row_mask:0xa bank_mask:0x1
    v_mov_b32_dpp v85, v77 row_shr:1 row_mask:0xa bank_mask:0x1
    v_mov_b32_dpp v86, v78 row_shr:1 row_mask:0xa bank_mask:0x1
    v_mov_b32_dpp v87, v79 row_shr:1 row_mask:0xa bank_mask:0x1
    v_cvt_pk_bf16_f32 v72, v192, v193
    v_cvt_pk_bf16_f32 v73, v194, v195
    v_cvt_pk_bf16_f32 v74, v196, v197
    v_cvt_pk_bf16_f32 v75, v198, v199
    v_cvt_pk_bf16_f32 v76, v200, v201
    v_cvt_pk_bf16_f32 v77, v202, v203
    v_cvt_pk_bf16_f32 v78, v204, v205
    v_cvt_pk_bf16_f32 v79, v206, v207
    v_mov_b32_dpp v88, v72 row_shr:1 row_mask:0xa bank_mask:0x1
    v_mov_b32_dpp v89, v73 row_shr:1 row_mask:0xa bank_mask:0x1
    v_mov_b32_dpp v90, v74 row_shr:1 row_mask:0xa bank_mask:0x1
    v_mov_b32_dpp v91, v75 row_shr:1 row_mask:0xa bank_mask:0x1
    v_mov_b32_dpp v92, v76 row_shr:1 row_mask:0xa bank_mask:0x1
    v_mov_b32_dpp v93, v77 row_shr:1 row_mask:0xa bank_mask:0x1
    v_mov_b32_dpp v94, v78 row_shr:1 row_mask:0xa bank_mask:0x1
    v_mov_b32_dpp v95, v79 row_shr:1 row_mask:0xa bank_mask:0x1
    v_cvt_pk_bf16_f32 v72, v144, v145
    v_cvt_pk_bf16_f32 v73, v146, v147
    v_cvt_pk_bf16_f32 v74, v148, v149
    v_cvt_pk_bf16_f32 v75, v150, v151
    v_cvt_pk_bf16_f32 v76, v152, v153
    v_cvt_pk_bf16_f32 v77, v154, v155
    v_cvt_pk_bf16_f32 v78, v156, v157
    v_cvt_pk_bf16_f32 v79, v158, v159
    v_mov_b32_dpp v80, v72 row_shr:2 row_mask:0xa bank_mask:0x1
    v_mov_b32_dpp v81, v73 row_shr:2 row_mask:0xa bank_mask:0x1
    v_mov_b32_dpp v82, v74 row_shr:2 row_mask:0xa bank_mask:0x1
    v_mov_b32_dpp v83, v75 row_shr:2 row_mask:0xa bank_mask:0x1
    v_mov_b32_dpp v84, v76 row_shr:2 row_mask:0xa bank_mask:0x1
    v_mov_b32_dpp v85, v77 row_shr:2 row_mask:0xa bank_mask:0x1
    v_mov_b32_dpp v86, v78 row_shr:2 row_mask:0xa bank_mask:0x1
    v_mov_b32_dpp v87, v79 row_shr:2 row_mask:0xa bank_mask:0x1
    v_cvt_pk_bf16_f32 v72, v208, v209
    v_cvt_pk_bf16_f32 v73, v210, v211
    v_cvt_pk_bf16_f32 v74, v212, v213
    v_cvt_pk_bf16_f32 v75, v214, v215
    v_cvt_pk_bf16_f32 v76, v216, v217
    v_cvt_pk_bf16_f32 v77, v218, v219
    v_cvt_pk_bf16_f32 v78, v220, v221
    v_cvt_pk_bf16_f32 v79, v222, v223
    v_mov_b32_dpp v88, v72 row_shr:2 row_mask:0xa bank_mask:0x1
    v_mov_b32_dpp v89, v73 row_shr:2 row_mask:0xa bank_mask:0x1
    v_mov_b32_dpp v90, v74 row_shr:2 row_mask:0xa bank_mask:0x1
    v_mov_b32_dpp v91, v75 row_shr:2 row_mask:0xa bank_mask:0x1
    v_mov_b32_dpp v92, v76 row_shr:2 row_mask:0xa bank_mask:0x1
    v_mov_b32_dpp v93, v77 row_shr:2 row_mask:0xa bank_mask:0x1
    v_mov_b32_dpp v94, v78 row_shr:2 row_mask:0xa bank_mask:0x1
    v_mov_b32_dpp v95, v79 row_shr:2 row_mask:0xa bank_mask:0x1
    v_cvt_pk_bf16_f32 v72, v160, v161
    v_cvt_pk_bf16_f32 v73, v162, v163
    v_cvt_pk_bf16_f32 v74, v164, v165
    v_cvt_pk_bf16_f32 v75, v166, v167
    v_cvt_pk_bf16_f32 v76, v168, v169
    v_cvt_pk_bf16_f32 v77, v170, v171
    v_cvt_pk_bf16_f32 v78, v172, v173
    v_cvt_pk_bf16_f32 v79, v174, v175
    v_mov_b32_dpp v80, v72 row_shr:3 row_mask:0xa bank_mask:0x1
    v_mov_b32_dpp v81, v73 row_shr:3 row_mask:0xa bank_mask:0x1
    v_mov_b32_dpp v82, v74 row_shr:3 row_mask:0xa bank_mask:0x1
    v_mov_b32_dpp v83, v75 row_shr:3 row_mask:0xa bank_mask:0x1
    v_mov_b32_dpp v84, v76 row_shr:3 row_mask:0xa bank_mask:0x1
    v_mov_b32_dpp v85, v77 row_shr:3 row_mask:0xa bank_mask:0x1
    v_mov_b32_dpp v86, v78 row_shr:3 row_mask:0xa bank_mask:0x1
    v_mov_b32_dpp v87, v79 row_shr:3 row_mask:0xa bank_mask:0x1
    v_cvt_pk_bf16_f32 v72, v224, v225
    v_cvt_pk_bf16_f32 v73, v226, v227
    v_cvt_pk_bf16_f32 v74, v228, v229
    v_cvt_pk_bf16_f32 v75, v230, v231
    v_cvt_pk_bf16_f32 v76, v232, v233
    v_cvt_pk_bf16_f32 v77, v234, v235
    v_cvt_pk_bf16_f32 v78, v236, v237
    v_cvt_pk_bf16_f32 v79, v238, v239
    v_mov_b32_dpp v88, v72 row_shr:3 row_mask:0xa bank_mask:0x1
    v_mov_b32_dpp v89, v73 row_shr:3 row_mask:0xa bank_mask:0x1
    v_mov_b32_dpp v90, v74 row_shr:3 row_mask:0xa bank_mask:0x1
    v_mov_b32_dpp v91, v75 row_shr:3 row_mask:0xa bank_mask:0x1
    v_mov_b32_dpp v92, v76 row_shr:3 row_mask:0xa bank_mask:0x1
    v_mov_b32_dpp v93, v77 row_shr:3 row_mask:0xa bank_mask:0x1
    v_mov_b32_dpp v94, v78 row_shr:3 row_mask:0xa bank_mask:0x1
    v_mov_b32_dpp v95, v79 row_shr:3 row_mask:0xa bank_mask:0x1
    s_nop 1
    v_mfma_f32_32x32x16_bf16 v[40:55], v[80:83], v[16:19], 0
    v_mfma_f32_32x32x16_bf16 v[40:55], v[84:87], v[20:23], v[40:55]
    v_mfma_f32_32x32x16_bf16 v[40:55], v[88:91], v[24:27], v[40:55]
    v_mfma_f32_32x32x16_bf16 v[40:55], v[92:95], v[28:31], v[40:55]
    v_mfma_f32_32x32x16_bf16 v[56:71], v[80:83], v[24:27], 0
    v_mfma_f32_32x32x16_bf16 v[56:71], v[84:87], v[28:31], v[56:71]
    v_mfma_f32_32x32x16_bf16 v[56:71], v[88:91], v[32:35], v[56:71]
    v_mfma_f32_32x32x16_bf16 v[56:71], v[92:95], v[36:39], v[56:71]
    s_add_u32 s30, s69, 4096
    s_nop 11
    v_cvt_pk_bf16_f32 v96, v48, v49
    v_cvt_pk_bf16_f32 v97, v50, v51
    v_cvt_pk_bf16_f32 v98, v64, v65
    v_cvt_pk_bf16_f32 v99, v66, v67
    s_mov_b32 exec_hi, 0
    buffer_store_dwordx4 v[96:99], v7, s[44:47], s30 offen sc1
    s_mov_b32 exec_hi, -1
P1_NOX:
    v_pk_add_f32 v[80:81], v[112:113], v[176:177]
    v_pk_add_f32 v[176:177], v[112:113], v[176:177] neg_lo:[0,1] neg_hi:[0,1]
    v_pk_add_f32 v[82:83], v[114:115], v[178:179]
    v_pk_add_f32 v[178:179], v[114:115], v[178:179] neg_lo:[0,1] neg_hi:[0,1]
    v_pk_add_f32 v[84:85], v[116:117], v[180:181]
    v_pk_add_f32 v[180:181], v[116:117], v[180:181] neg_lo:[0,1] neg_hi:[0,1]
    v_pk_add_f32 v[86:87], v[118:119], v[182:183]
    v_pk_add_f32 v[182:183], v[118:119], v[182:183] neg_lo:[0,1] neg_hi:[0,1]
    v_pk_add_f32 v[88:89], v[120:121], v[184:185]
    v_pk_add_f32 v[184:185], v[120:121], v[184:185] neg_lo:[0,1] neg_hi:[0,1]
    v_pk_add_f32 v[90:91], v[122:123], v[186:187]
    v_pk_add_f32 v[186:187], v[122:123], v[186:187] neg_lo:[0,1] neg_hi:[0,1]
    v_pk_add_f32 v[92:93], v[124:125], v[188:189]
    v_pk_add_f32 v[188:189], v[124:125], v[188:189] neg_lo:[0,1] neg_hi:[0,1]
    v_pk_add_f32 v[94:95], v[126:127], v[190:191]
    v_pk_add_f32 v[190:191], v[126:127], v[190:191] neg_lo:[0,1] neg_hi:[0,1]
    v_cvt_pk_bf16_f32 v40, v80, v81
    v_cvt_pk_bf16_f32 v48, v176, v177
    v_cvt_pk_bf16_f32 v41, v82, v83
    v_cvt_pk_bf16_f32 v49, v178, v179
    v_cvt_pk_bf16_f32 v42, v84, v85
    v_cvt_pk_bf16_f32 v50, v180, v181
    v_cvt_pk_bf16_f32 v43, v86, v87
    v_cvt_pk_bf16_f32 v51, v182, v183
    v_cvt_pk_bf16_f32 v44, v88, v89
    v_cvt_pk_bf16_f32 v52, v184, v185
    v_cvt_pk_bf16_f32 v45, v90, v91
    v_cvt_pk_bf16_f32 v53, v186, v187
    v_cvt_pk_bf16_f32 v46, v92, v93
    v_cvt_pk_bf16_f32 v54, v188, v189
    v_cvt_pk_bf16_f32 v47, v94, v95
    v_cvt_pk_bf16_f32 v55, v190, v191
    v_permlane16_swap_b32 v40, v48
    v_permlane16_swap_b32 v41, v49
    v_permlane16_swap_b32 v42, v50
    v_permlane16_swap_b32 v43, v51
    v_permlane16_swap_b32 v44, v52
    v_permlane16_swap_b32 v45, v53
    v_permlane16_swap_b32 v46, v54
    v_permlane16_swap_b32 v47, v55
    v_bitop3_b32 v48, v48, v5, v6 bitop3:0x28
    v_bitop3_b32 v49, v49, v5, v6 bitop3:0x28
    v_bitop3_b32 v50, v50, v5, v6 bitop3:0x28
    v_bitop3_b32 v51, v51, v5, v6 bitop3:0x28
    v_bitop3_b32 v52, v52, v5, v6 bitop3:0x28
    v_bitop3_b32 v53, v53, v5, v6 bitop3:0x28
    v_bitop3_b32 v54, v54, v5, v6 bitop3:0x28
    v_bitop3_b32 v55, v55, v5, v6 bitop3:0x28
    v_mfma_f32_32x32x16_bf16 v[112:127], v[16:19], v[40:43], 0
    v_pk_add_f32 v[80:81], v[128:129], v[192:193]
    v_pk_add_f32 v[192:193], v[128:129], v[192:193] neg_lo:[0,1] neg_hi:[0,1]
    v_pk_add_f32 v[82:83], v[130:131], v[194:195]
    v_pk_add_f32 v[194:195], v[130:131], v[194:195] neg_lo:[0,1] neg_hi:[0,1]
    v_pk_add_f32 v[84:85], v[132:133], v[196:197]
    v_pk_add_f32 v[196:197], v[132:133], v[196:197] neg_lo:[0,1] neg_hi:[0,1]
    v_mfma_f32_32x32x16_bf16 v[176:191], v[24:27], v[40:43], 0
    v_pk_add_f32 v[86:87], v[134:135], v[198:199]
    v_pk_add_f32 v[198:199], v[134:135], v[198:199] neg_lo:[0,1] neg_hi:[0,1]
    v_pk_add_f32 v[88:89], v[136:137], v[200:201]
    v_pk_add_f32 v[200:201], v[136:137], v[200:201] neg_lo:[0,1] neg_hi:[0,1]
    v_pk_add_f32 v[90:91], v[138:139], v[202:203]
    v_pk_add_f32 v[202:203], v[138:139], v[202:203] neg_lo:[0,1] neg_hi:[0,1]
    v_mfma_f32_32x32x16_bf16 v[112:127], v[20:23], v[44:47], v[112:127]
    v_pk_add_f32 v[92:93], v[140:141], v[204:205]
    v_pk_add_f32 v[204:205], v[140:141], v[204:205] neg_lo:[0,1] neg_hi:[0,1]
    v_pk_add_f32 v[94:95], v[142:143], v[206:207]
    v_pk_add_f32 v[206:207], v[142:143], v[206:207] neg_lo:[0,1] neg_hi:[0,1]
    v_cvt_pk_bf16_f32 v56, v80, v81
    v_cvt_pk_bf16_f32 v64, v192, v193
    v_mfma_f32_32x32x16_bf16 v[176:191], v[28:31], v[44:47], v[176:191]
    v_cvt_pk_bf16_f32 v57, v82, v83
    v_cvt_pk_bf16_f32 v65, v194, v195
    v_cvt_pk_bf16_f32 v58, v84, v85
    v_cvt_pk_bf16_f32 v66, v196, v197
    v_cvt_pk_bf16_f32 v59, v86, v87
    v_cvt_pk_bf16_f32 v67, v198, v199
    v_mfma_f32_32x32x16_bf16 v[112:127], v[24:27], v[48:51], v[112:127]
    v_cvt_pk_bf16_f32 v60, v88, v89
    v_cvt_pk_bf16_f32 v68, v200, v201
    v_cvt_pk_bf16_f32 v61, v90, v91
    v_cvt_pk_bf16_f32 v69, v202, v203
    v_cvt_pk_bf16_f32 v62, v92, v93
    v_cvt_pk_bf16_f32 v70, v204, v205
    v_mfma_f32_32x32x16_bf16 v[176:191], v[32:35], v[48:51], v[176:191]
    v_cvt_pk_bf16_f32 v63, v94, v95
    v_cvt_pk_bf16_f32 v71, v206, v207
    v_permlane16_swap_b32 v56, v64
    v_permlane16_swap_b32 v57, v65
    v_permlane16_swap_b32 v58, v66
    v_permlane16_swap_b32 v59, v67
    v_mfma_f32_32x32x16_bf16 v[112:127], v[28:31], v[52:55], v[112:127]
    v_permlane16_swap_b32 v60, v68
    v_permlane16_swap_b32 v61, v69
    v_permlane16_swap_b32 v62, v70
    v_permlane16_swap_b32 v63, v71
    v_bitop3_b32 v64, v64, v5, v6 bitop3:0x28
    v_bitop3_b32 v65, v65, v5, v6 bitop3:0x28
    v_mfma_f32_32x32x16_bf16 v[176:191], v[36:39], v[52:55], v[176:191]
    v_bitop3_b32 v66, v66, v5, v6 bitop3:0x28
    v_bitop3_b32 v67, v67, v5, v6 bitop3:0x28
    v_bitop3_b32 v68, v68, v5, v6 bitop3:0x28
    v_bitop3_b32 v69, v69, v5, v6 bitop3:0x28
    v_bitop3_b32 v70, v70, v5, v6 bitop3:0x28
    v_bitop3_b32 v71, v71, v5, v6 bitop3:0x28
    v_mfma_f32_32x32x16_bf16 v[128:143], v[16:19], v[56:59], 0
    v_pk_add_f32 v[80:81], v[144:145], v[208:209]
    v_pk_add_f32 v[208:209], v[144:145], v[208:209] neg_lo:[0,1] neg_hi:[0,1]
    v_pk_add_f32 v[82:83], v[146:147], v[210:211]
    v_pk_add_f32 v[210:211], v[146:147], v[210:211] neg_lo:[0,1] neg_hi:[0,1]
    v_pk_add_f32 v[84:85], v[148:149], v[212:213]
    v_pk_add_f32 v[212:213], v[148:149], v[212:213] neg_lo:[0,1] neg_hi:[0,1]
    v_mfma_f32_32x32x16_bf16 v[192:207], v[24:27], v[56:59], 0
    v_pk_add_f32 v[86:87], v[150:151], v[214:215]
    v_pk_add_f32 v[214:215], v[150:151], v[214:215] neg_lo:[0,1] neg_hi:[0,1]
    v_pk_add_f32 v[88:89], v[152:153], v[216:217]
    v_pk_add_f32 v[216:217], v[152:153], v[216:217] neg_lo:[0,1] neg_hi:[0,1]
    v_pk_add_f32 v[90:91], v[154:155], v[218:219]
    v_pk_add_f32 v[218:219], v[154:155], v[218:219] neg_lo:[0,1] neg_hi:[0,1]
    v_mfma_f32_32x32x16_bf16 v[128:143], v[20:23], v[60:63], v[128:143]
    v_pk_add_f32 v[92:93], v[156:157], v[220:221]
    v_pk_add_f32 v[220:221], v[156:157], v[220:221] neg_lo:[0,1] neg_hi:[0,1]
    v_pk_add_f32 v[94:95], v[158:159], v[222:223]
    v_pk_add_f32 v[222:223], v[158:159], v[222:223] neg_lo:[0,1] neg_hi:[0,1]
    v_cvt_pk_bf16_f32 v40, v80, v81
    v_cvt_pk_bf16_f32 v48, v208, v209
    v_mfma_f32_32x32x16_bf16 v[192:207], v[28:31], v[60:63], v[192:207]
    v_cvt_pk_bf16_f32 v41, v82, v83
    v_cvt_pk_bf16_f32 v49, v210, v211
    v_cvt_pk_bf16_f32 v42, v84, v85
    v_cvt_pk_bf16_f32 v50, v212, v213
    v_cvt_pk_bf16_f32 v43, v86, v87
    v_cvt_pk_bf16_f32 v51, v214, v215
    v_mfma_f32_32x32x16_bf16 v[128:143], v[24:27], v[64:67], v[128:143]
    v_cvt_pk_bf16_f32 v44, v88, v89
    v_cvt_pk_bf16_f32 v52, v216, v217
    v_cvt_pk_bf16_f32 v45, v90, v91
    v_cvt_pk_bf16_f32 v53, v218, v219
    v_cvt_pk_bf16_f32 v46, v92, v93
    v_cvt_pk_bf16_f32 v54, v220, v221
    v_mfma_f32_32x32x16_bf16 v[192:207], v[32:35], v[64:67], v[192:207]
    v_cvt_pk_bf16_f32 v47, v94, v95
    v_cvt_pk_bf16_f32 v55, v222, v223
    v_permlane16_swap_b32 v40, v48
    v_permlane16_swap_b32 v41, v49
    v_permlane16_swap_b32 v42, v50
    v_permlane16_swap_b32 v43, v51
    v_mfma_f32_32x32x16_bf16 v[128:143], v[28:31], v[68:71], v[128:143]
    v_permlane16_swap_b32 v44, v52
    v_permlane16_swap_b32 v45, v53
    v_permlane16_swap_b32 v46, v54
    v_permlane16_swap_b32 v47, v55
    v_bitop3_b32 v48, v48, v5, v6 bitop3:0x28
    v_bitop3_b32 v49, v49, v5, v6 bitop3:0x28
    v_mfma_f32_32x32x16_bf16 v[192:207], v[36:39], v[68:71], v[192:207]
    v_bitop3_b32 v50, v50, v5, v6 bitop3:0x28
    v_bitop3_b32 v51, v51, v5, v6 bitop3:0x28
    v_bitop3_b32 v52, v52, v5, v6 bitop3:0x28
    v_bitop3_b32 v53, v53, v5, v6 bitop3:0x28
    v_bitop3_b32 v54, v54, v5, v6 bitop3:0x28
    v_bitop3_b32 v55, v55, v5, v6 bitop3:0x28
    s_waitcnt lgkmcnt(0)
    s_and_b64 s[4:5], s[4:5], s[6:7]
    s_and_b64 s[8:9], s[8:9], s[10:11]
    s_and_b64 s[4:5], s[4:5], s[8:9]
    s_and_b32 s4, s4, s5
    s_cbranch_scc1 NOKS
    s_mov_b32 s48, s26
    s_mov_b32 s49, s27
    s_mov_b32 s50, 0x100
    s_mov_b32 s51, 0x20000
    s_mov_b32 s61, 0
    v_lshlrev_b32 v13, 2, v0
    s_mov_b64 exec, 0xff
NLS:
    v_mov_b32 v12, 0
    buffer_atomic_add v12, v13, s[48:51], 0 offen sc0 sc1
    s_add_u32 s61, s61, 1
    s_cmp_gt_u32 s61, 400000
    s_waitcnt vmcnt(0)
    s_cbranch_scc1 NXS
    v_cmp_eq_u32 vcc, 0, v12
    s_cbranch_vccnz NLS
NXS:
    s_mov_b64 exec, -1
NOKS:
    s_and_b32 s61, s56, 7
    s_lshl_b32 s61, s61, 3
    s_lshl_b32 s31, s66, 2
    s_add_u32 s61, s61, s31
    s_add_u32 s61, s61, 3
    s_lshl_b32 s30, s61, 7
    s_add_u32 s30, s30, 0x910000
    v_mov_b32 v12, 1
    v_lshlrev_b32 v13, 7, v0
    s_waitcnt vmcnt(0)
    s_mov_b64 exec, 1
    s_setprio 3
    buffer_atomic_add v12, v13, s[44:47], s30 offen sc1
    s_setprio 0
    s_mov_b64 exec, -1
    v_mfma_f32_32x32x16_bf16 v[144:159], v[16:19], v[40:43], 0
    v_pk_add_f32 v[80:81], v[160:161], v[224:225]
    v_pk_add_f32 v[224:225], v[160:161], v[224:225] neg_lo:[0,1] neg_hi:[0,1]
    v_pk_add_f32 v[82:83], v[162:163], v[226:227]
    v_pk_add_f32 v[226:227], v[162:163], v[226:227] neg_lo:[0,1] neg_hi:[0,1]
    v_pk_add_f32 v[84:85], v[164:165], v[228:229]
    v_pk_add_f32 v[228:229], v[164:165], v[228:229] neg_lo:[0,1] neg_hi:[0,1]
    v_mfma_f32_32x32x16_bf16 v[208:223], v[24:27], v[40:43], 0
    v_pk_add_f32 v[86:87], v[166:167], v[230:231]
    v_pk_add_f32 v[230:231], v[166:167], v[230:231] neg_lo:[0,1] neg_hi:[0,1]
    v_pk_add_f32 v[88:89], v[168:169], v[232:233]
    v_pk_add_f32 v[232:233], v[168:169], v[232:233] neg_lo:[0,1] neg_hi:[0,1]
    v_pk_add_f32 v[90:91], v[170:171], v[234:235]
    v_pk_add_f32 v[234:235], v[170:171], v[234:235] neg_lo:[0,1] neg_hi:[0,1]
    v_mfma_f32_32x32x16_bf16 v[144:159], v[20:23], v[44:47], v[144:159]
    v_pk_add_f32 v[92:93], v[172:173], v[236:237]
    v_pk_add_f32 v[236:237], v[172:173], v[236:237] neg_lo:[0,1] neg_hi:[0,1]
    v_pk_add_f32 v[94:95], v[174:175], v[238:239]
    v_pk_add_f32 v[238:239], v[174:175], v[238:239] neg_lo:[0,1] neg_hi:[0,1]
    v_cvt_pk_bf16_f32 v56, v80, v81
    v_cvt_pk_bf16_f32 v64, v224, v225
    v_mfma_f32_32x32x16_bf16 v[208:223], v[28:31], v[44:47], v[208:223]
    v_cvt_pk_bf16_f32 v57, v82, v83
    v_cvt_pk_bf16_f32 v65, v226, v227
    v_cvt_pk_bf16_f32 v58, v84, v85
    v_cvt_pk_bf16_f32 v66, v228, v229
    v_cvt_pk_bf16_f32 v59, v86, v87
    v_cvt_pk_bf16_f32 v67, v230, v231
    v_mfma_f32_32x32x16_bf16 v[144:159], v[24:27], v[48:51], v[144:159]
    v_cvt_pk_bf16_f32 v60, v88, v89
    v_cvt_pk_bf16_f32 v68, v232, v233
    v_cvt_pk_bf16_f32 v61, v90, v91
    v_cvt_pk_bf16_f32 v69, v234, v235
    v_cvt_pk_bf16_f32 v62, v92, v93
    v_cvt_pk_bf16_f32 v70, v236, v237
    v_mfma_f32_32x32x16_bf16 v[208:223], v[32:35], v[48:51], v[208:223]
    v_cvt_pk_bf16_f32 v63, v94, v95
    v_cvt_pk_bf16_f32 v71, v238, v239
    v_permlane16_swap_b32 v56, v64
    v_permlane16_swap_b32 v57, v65
    v_permlane16_swap_b32 v58, v66
    v_permlane16_swap_b32 v59, v67
    v_mfma_f32_32x32x16_bf16 v[144:159], v[28:31], v[52:55], v[144:159]
    v_permlane16_swap_b32 v60, v68
    v_permlane16_swap_b32 v61, v69
    v_permlane16_swap_b32 v62, v70
    v_permlane16_swap_b32 v63, v71
    v_bitop3_b32 v64, v64, v5, v6 bitop3:0x28
    v_bitop3_b32 v65, v65, v5, v6 bitop3:0x28
    v_mfma_f32_32x32x16_bf16 v[208:223], v[36:39], v[52:55], v[208:223]
    v_bitop3_b32 v66, v66, v5, v6 bitop3:0x28
    v_bitop3_b32 v67, v67, v5, v6 bitop3:0x28
    v_bitop3_b32 v68, v68, v5, v6 bitop3:0x28
    v_bitop3_b32 v69, v69, v5, v6 bitop3:0x28
    v_bitop3_b32 v70, v70, v5, v6 bitop3:0x28
    v_bitop3_b32 v71, v71, v5, v6 bitop3:0x28
    v_mfma_f32_32x32x16_bf16 v[160:175], v[16:19], v[56:59], 0
    v_mfma_f32_32x32x16_bf16 v[224:239], v[24:27], v[56:59], 0
    v_mfma_f32_32x32x16_bf16 v[160:175], v[20:23], v[60:63], v[160:175]
    v_mfma_f32_32x32x16_bf16 v[224:239], v[28:31], v[60:63], v[224:239]
    v_mfma_f32_32x32x16_bf16 v[160:175], v[24:27], v[64:67], v[160:175]
    v_mfma_f32_32x32x16_bf16 v[224:239], v[32:35], v[64:67], v[224:239]
    v_mfma_f32_32x32x16_bf16 v[160:175], v[28:31], v[68:71], v[160:175]
    v_mfma_f32_32x32x16_bf16 v[224:239], v[36:39], v[68:71], v[224:239]
    s_setprio 3
    s_nop 8
    v_cvt_pk_bf16_f32 v40, v112, v128
    v_cvt_pk_bf16_f32 v41, v144, v160
    v_cvt_pk_bf16_f32 v42, v176, v192
    v_cvt_pk_bf16_f32 v43, v208, v224
    s_add_u32 s30, s69, 0
    buffer_store_dwordx4 v[40:43], v4, s[44:47], s30 offen sc1
    v_cvt_pk_bf16_f32 v44, v113, v129
    v_cvt_pk_bf16_f32 v45, v145, v161
    v_cvt_pk_bf16_f32 v46, v177, v193
    v_cvt_pk_bf16_f32 v47, v209, v225
    s_add_u32 s30, s69, 67584
    buffer_store_dwordx4 v[44:47], v4, s[44:47], s30 offen sc1
    v_cvt_pk_bf16_f32 v48, v114, v130
    v_cvt_pk_bf16_f32 v49, v146, v162
    v_cvt_pk_bf16_f32 v50, v178, v194
    v_cvt_pk_bf16_f32 v51, v210, v226
    s_add_u32 s30, s69, 135168
    buffer_store_dwordx4 v[48:51], v4, s[44:47], s30 offen sc1
    v_cvt_pk_bf16_f32 v52, v115, v131
    v_cvt_pk_bf16_f32 v53, v147, v163
    v_cvt_pk_bf16_f32 v54, v179, v195
    v_cvt_pk_bf16_f32 v55, v211, v227
    s_add_u32 s30, s69, 202752
    buffer_store_dwordx4 v[52:55], v4, s[44:47], s30 offen sc1
    v_cvt_pk_bf16_f32 v56, v116, v132
    v_cvt_pk_bf16_f32 v57, v148, v164
    v_cvt_pk_bf16_f32 v58, v180, v196
    v_cvt_pk_bf16_f32 v59, v212, v228
    s_add_u32 s30, s69, 540672
    buffer_store_dwordx4 v[56:59], v4, s[44:47], s30 offen sc1
    v_cvt_pk_bf16_f32 v60, v117, v133
    v_cvt_pk_bf16_f32 v61, v149, v165
    v_cvt_pk_bf16_f32 v62, v181, v197
    v_cvt_pk_bf16_f32 v63, v213, v229
    s_add_u32 s30, s69, 608256
    buffer_store_dwordx4 v[60:63], v4, s[44:47], s30 offen sc1
    v_cvt_pk_bf16_f32 v64, v118, v134
    v_cvt_pk_bf16_f32 v65, v150, v166
    v_cvt_pk_bf16_f32 v66, v182, v198
    v_cvt_pk_bf16_f32 v67, v214, v230
    s_add_u32 s30, s69, 675840
    buffer_store_dwordx4 v[64:67], v4, s[44:47], s30 offen sc1
    v_cvt_pk_bf16_f32 v68, v119, v135
    v_cvt_pk_bf16_f32 v69, v151, v167
    v_cvt_pk_bf16_f32 v70, v183, v199
    v_cvt_pk_bf16_f32 v71, v215, v231
    s_add_u32 s30, s69, 743424
    buffer_store_dwordx4 v[68:71], v4, s[44:47], s30 offen sc1
    v_cvt_pk_bf16_f32 v40, v120, v136
    v_cvt_pk_bf16_f32 v41, v152, v168
    v_cvt_pk_bf16_f32 v42, v184, v200
    v_cvt_pk_bf16_f32 v43, v216, v232
    s_add_u32 s30, s69, 1081344
    buffer_store_dwordx4 v[40:43], v4, s[44:47], s30 offen sc1
    v_cvt_pk_bf16_f32 v44, v121, v137
    v_cvt_pk_bf16_f32 v45, v153, v169
    v_cvt_pk_bf16_f32 v46, v185, v201
    v_cvt_pk_bf16_f32 v47, v217, v233
    s_add_u32 s30, s69, 1148928
    buffer_store_dwordx4 v[44:47], v4, s[44:47], s30 offen sc1
    v_cvt_pk_bf16_f32 v48, v122, v138
    v_cvt_pk_bf16_f32 v49, v154, v170
    v_cvt_pk_bf16_f32 v50, v186, v202
    v_cvt_pk_bf16_f32 v51, v218, v234
    s_add_u32 s30, s69, 1216512
    buffer_store_dwordx4 v[48:51], v4, s[44:47], s30 offen sc1
    v_cvt_pk_bf16_f32 v52, v123, v139
    v_cvt_pk_bf16_f32 v53, v155, v171
    v_cvt_pk_bf16_f32 v54, v187, v203
    v_cvt_pk_bf16_f32 v55, v219, v235
    s_add_u32 s30, s69, 1284096
    buffer_store_dwordx4 v[52:55], v4, s[44:47], s30 offen sc1
    v_cvt_pk_bf16_f32 v56, v124, v140
    v_cvt_pk_bf16_f32 v57, v156, v172
    v_cvt_pk_bf16_f32 v58, v188, v204
    v_cvt_pk_bf16_f32 v59, v220, v236
    s_add_u32 s30, s69, 1622016
    buffer_store_dwordx4 v[56:59], v4, s[44:47], s30 offen sc1
    v_cvt_pk_bf16_f32 v60, v125, v141
    v_cvt_pk_bf16_f32 v61, v157, v173
    v_cvt_pk_bf16_f32 v62, v189, v205
    v_cvt_pk_bf16_f32 v63, v221, v237
    s_add_u32 s30, s69, 1689600
    buffer_store_dwordx4 v[60:63], v4, s[44:47], s30 offen sc1
    v_cvt_pk_bf16_f32 v64, v126, v142
    v_cvt_pk_bf16_f32 v65, v158, v174
    v_cvt_pk_bf16_f32 v66, v190, v206
    v_cvt_pk_bf16_f32 v67, v222, v238
    s_add_u32 s30, s69, 1757184
    buffer_store_dwordx4 v[64:67], v4, s[44:47], s30 offen sc1
    v_cvt_pk_bf16_f32 v68, v127, v143
    v_cvt_pk_bf16_f32 v69, v159, v175
    v_cvt_pk_bf16_f32 v70, v191, v207
    v_cvt_pk_bf16_f32 v71, v223, v239
    s_add_u32 s30, s69, 1824768
    buffer_store_dwordx4 v[68:71], v4, s[44:47], s30 offen sc1
    s_lshl_b32 s61, s59, 2
    s_add_u32 s61, s61, s3
    s_mul_i32 s61, s61, 32
    s_add_u32 s61, s61, 128
    s_lshl_b32 s30, s61, 7
    s_add_u32 s30, s30, 0x910000
    v_mov_b32 v12, 1
    v_lshlrev_b32 v13, 7, v0
    s_waitcnt vmcnt(0)
    s_mov_b32 exec_lo, -1
    s_mov_b32 exec_hi, 0
    s_setprio 3
    buffer_atomic_add v12, v13, s[44:47], s30 offen sc1
    s_setprio 0
    s_mov_b64 exec, -1
    s_setprio 0
    s_and_b32 s30, s2, 7
    s_lshr_b32 s31, s2, 3
    s_lshr_b32 s93, s31, 2
    s_xor_b32 s93, s93, 5
    s_and_b32 s31, s31, 3
    s_mul_i32 s94, s31, 6
    s_sub_u32 s61, 0, s30
    s_bitcmp1_b32 s31, 0
    s_cselect_b32 s92, s61, s30
    s_cselect_b32 s61, 8, 0
    s_cmp_eq_u32 s30, 0
    s_cselect_b32 s92, s61, s92
    s_lshr_b32 s31, s31, 1
    s_lshl_b32 s31, s31, 4
    s_add_u32 s92, s92, s31
    s_and_b32 s92, s92, 31
    s_mul_i32 s30, s93, 0
    s_add_u32 s94, s94, s30
    s_sub_u32 s30, s94, 22
    s_cmp_ge_u32 s94, 22
    s_cselect_b32 s94, s30, s94
    v_lshrrev_b32 v228, 5, v0
    v_and_b32 v229, 31, v0
    s_lshl_b32 s31, s93, 6
    s_lshl_b32 s61, s67, 5
    s_add_u32 s31, s31, s61
    s_lshl_b32 s30, s66, 5
    s_add_u32 s30, s30, s92
    v_lshlrev_b32 v232, 6, v229
    v_add_u32 v232, s30, v232
    v_lshrrev_b32 v231, 1, v229
    v_lshlrev_b32 v231, 7, v231
    v_and_b32 v224, 1, v229
    v_lshl_add_u32 v231, v224, 2, v231
    s_lshl_b32 s61, s30, 11
    v_add_u32 v231, s61, v231
    s_lshr_b32 s64, s30, 2
    s_sub_u32 s61, 32, s92
    s_and_b32 s61, s61, 31
    s_sub_u32 s65, 481, s31
    s_cmp_ge_u32 s93, 4
    s_cselect_b32 s79, s61, s92
    s_cselect_b64 vcc, -1, 0
    s_cselect_b32 s76, 1.0, -1.0
    s_cselect_b32 s65, s65, s31
    v_add_u32 v224, s31, v229
    v_sub_u32 v225, 0x200, v224
    v_cndmask_b32 v224, v224, v225, vcc
    v_lshrrev_b32 v226, 4, v0
    v_lshlrev_b32 v226, 4, v226
    v_min_u32 v226, 31, v226
    v_add_u32 v226, s65, v226
    v_sub_u32 v225, 384, v224
    v_cmp_gt_u32 vcc, 128, v224
    s_nop 1
    v_cndmask_b32 v224, v225, v224, vcc
    v_sub_u32 v225, 384, v226
    v_cmp_gt_u32 vcc, 128, v226
    s_nop 1
    v_cndmask_b32 v226, v225, v226, vcc
    v_mul_u32_u24 v225, 2112, v228
    v_add_u32 v224, v224, v225
    v_lshlrev_b32 v224, 4, v224
    s_mul_i32 s79, s79, 67584
    s_add_u32 s79, s79, 0x600000
    v_bfe_u32 v226, v226, 4, 3
    s_lshr_b32 s61, s2, 1
    s_xor_b32 s61, s61, s2
    s_lshl_b32 s64, s66, 4
    s_add_u32 s61, s61, s64
    s_and_b32 s61, s61, 31
    s_add_u32 s61, s61, 128
    v_lshl_add_u32 v226, v226, 5, s61
    s_add_u32 s61, s30, 64
    v_mov_b32 v225, s61
    v_cmp_gt_u32 vcc, 48, v0
    s_nop 1
    v_cndmask_b32 v226, v225, v226, vcc
    v_lshlrev_b32 v226, 7, v226
    v_cvt_f32_u32 v229, v232
    v_mul_f32 v229, 0x3a000000, v229
    v_mul_f32 v229, s76, v229
    v_lshlrev_b32 v230, 5, v228
    v_cvt_f32_u32 v230, v230
    v_mul_f32 v230, v230, v229
    v_cos_f32 v16, v230
    v_sin_f32 v20, v230
    v_add_f32 v230, v230, v229
    v_cos_f32 v17, v230
    v_sin_f32 v21, v230
    v_add_f32 v230, v230, v229
    v_cos_f32 v18, v230
    v_sin_f32 v22, v230
    v_add_f32 v230, v230, v229
    v_cos_f32 v19, v230
    v_sin_f32 v23, v230
    v_add_f32 v230, v230, v229
    v_cvt_pk_bf16_f32 v192, v16, v17
    v_cvt_pk_bf16_f32 v193, v18, v19
    v_cvt_pk_bf16_f32 v194, v20, v21
    v_cvt_pk_bf16_f32 v195, v22, v23
    v_cos_f32 v16, v230
    v_sin_f32 v20, v230
    v_add_f32 v230, v230, v229
    v_cos_f32 v17, v230
    v_sin_f32 v21, v230
    v_add_f32 v230, v230, v229
    v_cos_f32 v18, v230
    v_sin_f32 v22, v230
    v_add_f32 v230, v230, v229
    v_cos_f32 v19, v230
    v_sin_f32 v23, v230
    v_add_f32 v230, v230, v229
    v_cvt_pk_bf16_f32 v196, v16, v17
    v_cvt_pk_bf16_f32 v197, v18, v19
    v_cvt_pk_bf16_f32 v198, v20, v21
    v_cvt_pk_bf16_f32 v199, v22, v23
    v_cos_f32 v16, v230
    v_sin_f32 v20, v230
    v_add_f32 v230, v230, v229
    v_cos_f32 v17, v230
    v_sin_f32 v21, v230
    v_add_f32 v230, v230, v229
    v_cos_f32 v18, v230
    v_sin_f32 v22, v230
    v_add_f32 v230, v230, v229
    v_cos_f32 v19, v230
    v_sin_f32 v23, v230
    v_add_f32 v230, v230, v229
    v_cvt_pk_bf16_f32 v200, v16, v17
    v_cvt_pk_bf16_f32 v201, v18, v19
    v_cvt_pk_bf16_f32 v202, v20, v21
    v_cvt_pk_bf16_f32 v203, v22, v23
    v_cos_f32 v16, v230
    v_sin_f32 v20, v230
    v_add_f32 v230, v230, v229
    v_cos_f32 v17, v230
    v_sin_f32 v21, v230
    v_add_f32 v230, v230, v229
    v_cos_f32 v18, v230
    v_sin_f32 v22, v230
    v_add_f32 v230, v230, v229
    v_cos_f32 v19, v230
    v_sin_f32 v23, v230
    v_add_f32 v230, v230, v229
    v_cvt_pk_bf16_f32 v204, v16, v17
    v_cvt_pk_bf16_f32 v205, v18, v19
    v_cvt_pk_bf16_f32 v206, v20, v21
    v_cvt_pk_bf16_f32 v207, v22, v23
    v_cos_f32 v16, v230
    v_sin_f32 v20, v230
    v_add_f32 v230, v230, v229
    v_cos_f32 v17, v230
    v_sin_f32 v21, v230
    v_add_f32 v230, v230, v229
    v_cos_f32 v18, v230
    v_sin_f32 v22, v230
    v_add_f32 v230, v230, v229
    v_cos_f32 v19, v230
    v_sin_f32 v23, v230
    v_add_f32 v230, v230, v229
    v_cvt_pk_bf16_f32 v208, v16, v17
    v_cvt_pk_bf16_f32 v209, v18, v19
    v_cvt_pk_bf16_f32 v210, v20, v21
    v_cvt_pk_bf16_f32 v211, v22, v23
    v_cos_f32 v16, v230
    v_sin_f32 v20, v230
    v_add_f32 v230, v230, v229
    v_cos_f32 v17, v230
    v_sin_f32 v21, v230
    v_add_f32 v230, v230, v229
    v_cos_f32 v18, v230
    v_sin_f32 v22, v230
    v_add_f32 v230, v230, v229
    v_cos_f32 v19, v230
    v_sin_f32 v23, v230
    v_add_f32 v230, v230, v229
    v_cvt_pk_bf16_f32 v212, v16, v17
    v_cvt_pk_bf16_f32 v213, v18, v19
    v_cvt_pk_bf16_f32 v214, v20, v21
    v_cvt_pk_bf16_f32 v215, v22, v23
    v_cos_f32 v16, v230
    v_sin_f32 v20, v230
    v_add_f32 v230, v230, v229
    v_cos_f32 v17, v230
    v_sin_f32 v21, v230
    v_add_f32 v230, v230, v229
    v_cos_f32 v18, v230
    v_sin_f32 v22, v230
    v_add_f32 v230, v230, v229
    v_cos_f32 v19, v230
    v_sin_f32 v23, v230
    v_add_f32 v230, v230, v229
    v_cvt_pk_bf16_f32 v216, v16, v17
    v_cvt_pk_bf16_f32 v217, v18, v19
    v_cvt_pk_bf16_f32 v218, v20, v21
    v_cvt_pk_bf16_f32 v219, v22, v23
    v_cos_f32 v16, v230
    v_sin_f32 v20, v230
    v_add_f32 v230, v230, v229
    v_cos_f32 v17, v230
    v_sin_f32 v21, v230
    v_add_f32 v230, v230, v229
    v_cos_f32 v18, v230
    v_sin_f32 v22, v230
    v_add_f32 v230, v230, v229
    v_cos_f32 v19, v230
    v_sin_f32 v23, v230
    v_add_f32 v230, v230, v229
    v_cvt_pk_bf16_f32 v220, v16, v17
    v_cvt_pk_bf16_f32 v221, v18, v19
    v_cvt_pk_bf16_f32 v222, v20, v21
    v_cvt_pk_bf16_f32 v223, v22, v23
    s_lshr_b32 s30, s95, 2
    v_lshrrev_b32 v248, 3, v0
    s_lshl_b32 s31, s3, 3
    v_add_u32 v248, s31, v248
    v_and_b32 v249, 3, v0
    v_lshlrev_b32 v250, 2, v249
    v_xor_b32 v250, v250, v248
    v_lshlrev_b32 v250, 4, v250
    v_lshl_add_u32 v250, v249, 10, v250
    v_bfe_u32 v249, v0, 2, 1
    s_lshl_b32 s31, s30, 1
    v_add_u32 v249, s31, v249
    v_mul_u32_u24 v251, 10240, v249
    v_add_u32 v251, v251, v250
    v_mul_u32_u24 v249, 40960, v249
    v_add_u32 v249, v249, v250
    s_lshl_b32 s31, s30, 7
    v_lshl_add_u32 v250, v248, 2, s31
    s_lshl_b32 s30, s30, 5
    s_add_u32 s30, s30, s92
    s_lshl_b32 s30, s30, 10
    s_lshl_b32 s31, s93, 7
    s_add_u32 s30, s30, s31
    v_lshlrev_b32 v248, 16, v248
    v_add_u32 v248, s30, v248
    v_and_b32 v252, 7, v0
    v_lshl_add_u32 v248, v252, 4, v248
    s_mul_i32 s30, s3, 10240
    s_add_u32 s30, s30, 4096
    v_lshlrev_b32 v225, 4, v0
    v_add_u32 v240, s30, v225
    v_xor_b32 v241, 64, v240
    v_xor_b32 v242, 128, v240
    v_xor_b32 v243, 192, v240
    v_and_b32 v225, 31, v0
    s_lshl_b32 s30, s66, 7
    v_lshl_add_u32 v244, v225, 2, s30
P2_CONS:
    v_mov_b32 v56, 16
    s_barrier
    s_setprio 3
    s_mov_b32 s30, 0x910000
    s_mov_b32 s61, 0
    s_mov_b32 exec_lo, 0x10001
    s_mov_b32 exec_hi, 0x10001
PLC:
    v_mov_b32 v58, 0
    buffer_atomic_add v58, v226, s[44:47], s30 offen sc0 sc1
    s_add_u32 s61, s61, 1
    s_cmp_gt_u32 s61, 400000
    s_waitcnt vmcnt(0)
    s_cbranch_scc1 PDC
    v_cmp_ne_u32 vcc, v58, v56
    s_cbranch_vccnz PLC
PDC:
    s_mov_b64 exec, -1
    s_add_u32 s70, s79, 0
    buffer_load_dwordx4 v[80:83], v224, s[44:47], s70 offen sc1
    s_add_u32 s70, s79, 4224
    buffer_load_dwordx4 v[84:87], v224, s[44:47], s70 offen sc1
    s_add_u32 s70, s79, 8448
    buffer_load_dwordx4 v[88:91], v224, s[44:47], s70 offen sc1
    s_add_u32 s70, s79, 12672
    buffer_load_dwordx4 v[92:95], v224, s[44:47], s70 offen sc1
    s_add_u32 s70, s79, 16896
    buffer_load_dwordx4 v[96:99], v224, s[44:47], s70 offen sc1
    s_add_u32 s70, s79, 21120
    buffer_load_dwordx4 v[100:103], v224, s[44:47], s70 offen sc1
    s_add_u32 s70, s79, 25344
    buffer_load_dwordx4 v[104:107], v224, s[44:47], s70 offen sc1
    s_add_u32 s70, s79, 29568
    buffer_load_dwordx4 v[108:111], v224, s[44:47], s70 offen sc1
    s_mov_b32 s70, 0x8e0000
    buffer_load_dword v60, v231, s[44:47], s70 offen sc1
    s_waitcnt vmcnt(8)
    v_mfma_f32_32x32x16_bf16 v[64:79], v[80:83], v[192:195], 0
    s_waitcnt vmcnt(7)
    v_mfma_f32_32x32x16_bf16 v[64:79], v[84:87], v[196:199], v[64:79]
    s_waitcnt vmcnt(6)
    v_mfma_f32_32x32x16_bf16 v[64:79], v[88:91], v[200:203], v[64:79]
    s_waitcnt vmcnt(5)
    v_mfma_f32_32x32x16_bf16 v[64:79], v[92:95], v[204:207], v[64:79]
    s_waitcnt vmcnt(4)
    v_mfma_f32_32x32x16_bf16 v[64:79], v[96:99], v[208:211], v[64:79]
    s_waitcnt vmcnt(3)
    v_mfma_f32_32x32x16_bf16 v[64:79], v[100:103], v[212:215], v[64:79]
    s_waitcnt vmcnt(2)
    v_mfma_f32_32x32x16_bf16 v[64:79], v[104:107], v[216:219], v[64:79]
    s_waitcnt vmcnt(1)
    v_mfma_f32_32x32x16_bf16 v[64:79], v[108:111], v[220:223], v[64:79]
    s_waitcnt vmcnt(0)
    v_sub_f32 v62, 1.0, v60
    v_cvt_pk_bf16_f32 v62, v62, v62
    v_lshlrev_b32 v62, 16, v62
    ds_write_b32 v244, v62 offset:8192
    s_nop 6
    v_pk_mul_f32 v[64:65], v[64:65], v[60:61] op_sel_hi:[1,0]
    v_pk_mul_f32 v[66:67], v[66:67], v[60:61] op_sel_hi:[1,0]
    ds_write_b128 v240, v[64:67] offset:0
    v_pk_mul_f32 v[68:69], v[68:69], v[60:61] op_sel_hi:[1,0]
    v_pk_mul_f32 v[70:71], v[70:71], v[60:61] op_sel_hi:[1,0]
    ds_write_b128 v241, v[68:71] offset:1024
    v_pk_mul_f32 v[72:73], v[72:73], v[60:61] op_sel_hi:[1,0]
    v_pk_mul_f32 v[74:75], v[74:75], v[60:61] op_sel_hi:[1,0]
    ds_write_b128 v242, v[72:75] offset:2048
    v_pk_mul_f32 v[76:77], v[76:77], v[60:61] op_sel_hi:[1,0]
    v_pk_mul_f32 v[78:79], v[78:79], v[60:61] op_sel_hi:[1,0]
    ds_write_b128 v243, v[76:79] offset:3072
    s_waitcnt lgkmcnt(0)
    s_barrier
    s_mov_b32 s48, s24
    s_mov_b32 s49, s25
    s_mov_b32 s50, 0x200000
    s_mov_b32 s51, 0x20000
    ds_read_b32 v252, v250 offset:8192
    ds_read_b128 v[144:147], v249 offset:0
    ds_read_b128 v[152:155], v249 offset:10240
    ds_read_b128 v[160:163], v249 offset:20480
    ds_read_b128 v[168:171], v249 offset:30720
    ds_read_b128 v[176:179], v251 offset:4096
    ds_read_b128 v[148:151], v249 offset:512
    ds_read_b128 v[156:159], v249 offset:10752
    ds_read_b128 v[164:167], v249 offset:20992
    ds_read_b128 v[172:175], v249 offset:31232
    ds_read_b128 v[180:183], v251 offset:4608
    s_waitcnt lgkmcnt(5)
    v_pk_add_f32 v[144:145], v[144:145], v[152:153]
    v_pk_add_f32 v[160:161], v[160:161], v[168:169]
    v_pk_add_f32 v[146:147], v[146:147], v[154:155]
    v_pk_add_f32 v[162:163], v[162:163], v[170:171]
    v_pk_add_f32 v[144:145], v[144:145], v[160:161]
    v_pk_add_f32 v[146:147], v[146:147], v[162:163]
    v_fma_f32 v144, v252, v144, v176
    v_fma_f32 v145, v252, v145, v177
    v_fma_f32 v146, v252, v146, v178
    v_fma_f32 v147, v252, v147, v179
    v_cvt_pk_bf16_f32 v184, v144, v145
    v_cvt_pk_bf16_f32 v185, v146, v147
    s_waitcnt lgkmcnt(0)
    v_pk_add_f32 v[148:149], v[148:149], v[156:157]
    v_pk_add_f32 v[164:165], v[164:165], v[172:173]
    v_pk_add_f32 v[150:151], v[150:151], v[158:159]
    v_pk_add_f32 v[166:167], v[166:167], v[174:175]
    v_pk_add_f32 v[148:149], v[148:149], v[164:165]
    v_pk_add_f32 v[150:151], v[150:151], v[166:167]
    v_fma_f32 v148, v252, v148, v180
    v_fma_f32 v149, v252, v149, v181
    v_fma_f32 v150, v252, v150, v182
    v_fma_f32 v151, v252, v151, v183
    v_cvt_pk_bf16_f32 v186, v148, v149
    v_cvt_pk_bf16_f32 v187, v150, v151
    buffer_store_dwordx4 v[184:187], v248, s[48:51], 0 offen sc1
K_END:
    s_endpgm
.section .rodata,"a"
.p2align 6
.amdhsa_kernel gated_mix__spectral_fnet__geglu_ffn__prompt_kernel
  .amdhsa_next_free_vgpr 256
  .amdhsa_next_free_sgpr 102
  .amdhsa_accum_offset 256
  .amdhsa_group_segment_fixed_size 0
  .amdhsa_kernarg_size 104
  .amdhsa_user_sgpr_count 2
  .amdhsa_user_sgpr_kernarg_segment_ptr 1
  .amdhsa_system_sgpr_workgroup_id_x 1
.end_amdhsa_kernel
```
